```python
import torch

def _softmax(x, axis=-1):
    return torch.softmax(x, dim=axis)
def _gelu(x):
    return torch.nn.functional.gelu(x, approximate="tanh")
def _silu(x):
    return torch.nn.functional.silu(x)
def _sigmoid(x):
    return torch.sigmoid(x)
def _layernorm(x, axis=-1, eps=1e-5):
    m = x.mean(dim=axis, keepdim=True)
    v = x.var(dim=axis, keepdim=True, unbiased=False)
    return (x - m) / torch.sqrt(v + eps)
def _scatter_add(tgt, idx, src, axis=0):
    return tgt.clone().index_add_(axis, idx, src)
def _segment_sum(src, seg, n):
    out = torch.zeros((n,) + src.shape[1:], dtype=src.dtype)
    return out.index_add_(0, seg, src)
def _pad(x, pw):
    flat = tuple(v for pair in reversed(pw) for v in pair)
    return torch.nn.functional.pad(x, flat)

kernel_name = 'sequential_preLN__mha_block__glu_gated_geglu__prompt'

def setup_inputs():

    _w = (lambda a: (lambda t: t.to(torch.bfloat16) if t.is_floating_point() else t)(torch.as_tensor(a)))
    def _A_setup():
        B, S, D, H = 1, 2048, 640, 32
        return {
            "x": _w((lambda *s: torch.randn(*s, dtype=torch.bfloat16) * 0.05)(B, S, D)),
            "wqkv": _w((lambda *s: torch.randn(*s, dtype=torch.bfloat16) * 0.05)(D, 3 * D)),
            "wo": _w((lambda *s: torch.randn(*s, dtype=torch.bfloat16) * 0.05)(D, D)),
        }
    _A_in = _A_setup()

    def _B_setup():
        B, S, Dm, Df = 1, 2048, 640, 1536
        return {
            "x": _w((lambda *s: torch.randn(*s, dtype=torch.bfloat16) * 0.05)(B, S, Dm)),
            "w_gate": _w((lambda *s: torch.randn(*s, dtype=torch.bfloat16) * 0.8)(Dm, Df) * (Dm ** -0.5)),
            "w_up": _w((lambda *s: torch.randn(*s, dtype=torch.bfloat16) * 0.8)(Dm, Df) * (Dm ** -0.5)),
            "w_down": _w((lambda *s: torch.randn(*s, dtype=torch.bfloat16) * 0.8)(Df, Dm) * (Df ** -0.5)),
        }
    _B_in = _B_setup()

    return {
        "A_x": _A_in["x"],
        "A_wqkv": _A_in["wqkv"],
        "A_wo": _A_in["wo"],
        "B_x": _B_in["x"],
        "B_w_gate": _B_in["w_gate"],
        "B_w_up": _B_in["w_up"],
        "B_w_down": _B_in["w_down"],
    }

def reference(A_x, A_wqkv, A_wo, B_x, B_w_gate, B_w_up, B_w_down):
    def _A_ref(x, wqkv, wo):
        B, S, D = x.shape
        H = 32
        Dh = D // H
        qkv = (lambda x, *d: x.permute(*d))((x @ wqkv).reshape(B, S, 3, H, Dh), 2, 0, 3, 1, 4)
        q, k, v = qkv[0], qkv[1], qkv[2]
        scores = torch.einsum("bhqd,bhkd->bhqk", q, k) * (Dh ** -0.5)
        p = _softmax(scores, axis=-1)
        o = torch.einsum("bhqk,bhkd->bhqd", p, v)
        return (lambda x, *d: x.permute(*d))(o, 0, 2, 1, 3).reshape(B, S, D) @ wo

    def _B_ref(x, w_gate, w_up, w_down):
        g = torch.einsum("bsd,df->bsf", x, w_gate)
        u = torch.einsum("bsd,df->bsf", x, w_up)
        h = _gelu(g) * u
        return torch.einsum("bsf,fd->bsd", h, w_down)

    x = A_x
    h = x + _A_ref(_layernorm(x, axis=-1), A_wqkv, A_wo)
    h2 = h + _B_ref(_layernorm(h, axis=-1), B_w_gate, B_w_up, B_w_down)
    return h2
```

```asm
; @launch grid=(256,1,1) block=(768,1,1) lds=163840
.amdgcn_target "amdgcn-amd-amdhsa--gfx950"
.text
.globl sequential_preLN__mha_block__glu_gated_geglu__prompt_kernel
.p2align 8
.type sequential_preLN__mha_block__glu_gated_geglu__prompt_kernel,@function
sequential_preLN__mha_block__glu_gated_geglu__prompt_kernel:
    s_cmp_ge_u32 s2, 256
    s_cbranch_scc1 sequential_preLN__mha_block__glu_gated_geglu__prompt_kernel_exit
    s_load_dwordx4 s[40:43], s[0:1], 0
    s_load_dwordx2 s[4:5], s[0:1], 72
    v_lshrrev_b32 v1, 6, v0
    v_and_b32 v0, 63, v0
    v_readfirstlane_b32 s20, v1
    s_bfe_u32 s21, s2, 0x20001
    s_lshl_b32 s21, s21, 2
    s_bfe_u32 s31, s2, 0x20003
    s_add_u32 s21, s21, s31
    s_and_b32 s22, s2, 1
    s_lshl_b32 s22, s22, 3
    s_lshr_b32 s31, s2, 5
    s_add_u32 s22, s22, s31
    s_add_u32 s22, s22, 15
    s_and_b32 s22, s22, 15
    s_cmp_lt_u32 s20, 8
    s_cbranch_scc1 sequential_preLN__mha_block__glu_gated_geglu__prompt_kernel_notloader
    s_sub_u32 s20, s20, 8
    v_lshrrev_b32 v2, 3, v0
    v_mul_u32_u24 v2, 1280, v2
    v_lshrrev_b32 v3, 4, v0
    v_and_b32 v4, 7, v0
    v_xor_b32 v4, v4, v3
    v_lshl_add_u32 v18, v4, 4, v2
    v_xor_b32 v4, 4, v4
    v_lshl_add_u32 v19, v4, 4, v2
    v_add_u32 v19, 9216, v19
    v_add_u32 v20, 18432, v18
    v_add_u32 v21, 18432, v19
    v_lshlrev_b32 v4, 2, v3
    v_sub_u32 v4, v0, v4
    v_and_b32 v4, 15, v4
    s_lshl_b32 s26, s21, 2
    s_add_u32 s26, s26, s20
    s_mul_i32 s26, s26, 40960
    s_mul_i32 s27, s20, 61440
    s_lshl_b32 s31, s22, 8
    s_add_u32 s27, s27, s31
    s_cmp_ge_u32 s22, 10
    s_cbranch_scc1 sequential_preLN__mha_block__glu_gated_geglu__prompt_kernel_srcdone
    s_cmp_ge_u32 s22, 5
    s_cselect_b32 s39, 5, 0
    s_sub_u32 s39, s22, s39
    s_sub_u32 s46, 7, s39
    s_cmp_ge_u32 s46, 5
    s_cselect_b32 s3, 5, 0
    s_sub_u32 s46, s46, s3
    v_and_b32 v6, 3, v4
    v_cmp_le_u32 vcc, s46, v6
    v_lshrrev_b32 v5, 2, v4
    v_mul_u32_u24 v6, 5, v6
    v_addc_co_u32 v5, vcc, v4, v5, vcc
    v_add_u32 v6, s46, v6
    v_min_u32 v6, 15, v6
    v_cmp_eq_u32 vcc, 15, v4
    v_cmp_le_u32 s[48:49], 12, v4
    s_nop 0
    v_cndmask_b32 v6, v6, v4, vcc
    v_cndmask_b32 v4, v5, v6, s[48:49]
sequential_preLN__mha_block__glu_gated_geglu__prompt_kernel_srcdone:
    v_mul_u32_u24 v3, 3840, v3
    v_lshl_add_u32 v22, v4, 4, v3
    v_add_u32 v23, 14336, v22
    v_add_u32 v24, 28672, v22
    v_add_u32 v25, 43008, v22
    s_lshl_b32 s28, s20, 12
    s_waitcnt lgkmcnt(0)
    s_mov_b32 s12, s40
    s_and_b32 s13, s41, 0xffff
    s_mov_b32 s14, 2621440
    s_mov_b32 s15, 0x20000
    s_mov_b32 s16, s42
    s_and_b32 s17, s43, 0xffff
    s_mov_b32 s18, 2457600
    s_mov_b32 s19, 0x20000
    s_cmp_eq_u32 s22, 15
    s_cselect_b32 s26, 1073741824, s26
    s_cselect_b32 s27, 1073741824, s27
    s_mov_b32 m0, s28
    s_add_u32 s31, s28, 16384
    buffer_load_dwordx4 v18, s[12:15], s26 offen offset:0 lds
    buffer_load_dwordx4 v19, s[12:15], s26 offen offset:1024 lds
    buffer_load_dwordx4 v20, s[12:15], s26 offen offset:2048 lds
    buffer_load_dwordx4 v21, s[12:15], s26 offen offset:3072 lds
    s_mov_b32 m0, s31
    s_add_u32 s26, s26, 128
    buffer_load_dwordx4 v22, s[16:19], s27 offen offset:0 lds
    buffer_load_dwordx4 v23, s[16:19], s27 offen offset:1024 lds
    buffer_load_dwordx4 v24, s[16:19], s27 offen offset:2048 lds
    buffer_load_dwordx4 v25, s[16:19], s27 offen offset:3072 lds
    s_add_u32 s27, s27, 245760
    s_add_u32 s28, s28, 32768
    s_and_b32 s28, s28, 131071
    s_mov_b32 m0, s28
    s_add_u32 s31, s28, 16384
    buffer_load_dwordx4 v18, s[12:15], s26 offen offset:0 lds
    buffer_load_dwordx4 v19, s[12:15], s26 offen offset:1024 lds
    buffer_load_dwordx4 v20, s[12:15], s26 offen offset:2048 lds
    buffer_load_dwordx4 v21, s[12:15], s26 offen offset:3072 lds
    s_mov_b32 m0, s31
    s_add_u32 s26, s26, 128
    buffer_load_dwordx4 v22, s[16:19], s27 offen offset:0 lds
    buffer_load_dwordx4 v23, s[16:19], s27 offen offset:1024 lds
    buffer_load_dwordx4 v24, s[16:19], s27 offen offset:2048 lds
    buffer_load_dwordx4 v25, s[16:19], s27 offen offset:3072 lds
    s_add_u32 s27, s27, 245760
    s_add_u32 s28, s28, 32768
    s_and_b32 s28, s28, 131071
    s_mov_b32 s8, s4
    s_and_b32 s9, s5, 0xffff
    s_mov_b32 s10, 22433792
    s_mov_b32 s11, 0x20000
    s_load_dwordx2 s[44:45], s[0:1], 16
    s_load_dwordx2 s[56:57], s[0:1], 48
    s_waitcnt vmcnt(8)
    s_barrier
    s_mov_b32 m0, s28
    s_add_u32 s31, s28, 16384
    buffer_load_dwordx4 v18, s[12:15], s26 offen offset:0 lds
    buffer_load_dwordx4 v19, s[12:15], s26 offen offset:1024 lds
    buffer_load_dwordx4 v20, s[12:15], s26 offen offset:2048 lds
    buffer_load_dwordx4 v21, s[12:15], s26 offen offset:3072 lds
    s_mov_b32 m0, s31
    s_add_u32 s26, s26, 128
    buffer_load_dwordx4 v22, s[16:19], s27 offen offset:0 lds
    buffer_load_dwordx4 v23, s[16:19], s27 offen offset:1024 lds
    buffer_load_dwordx4 v24, s[16:19], s27 offen offset:2048 lds
    buffer_load_dwordx4 v25, s[16:19], s27 offen offset:3072 lds
    s_add_u32 s27, s27, 245760
    s_add_u32 s28, s28, 32768
    s_and_b32 s28, s28, 131071
    s_mov_b32 m0, s28
    s_add_u32 s31, s28, 16384
    buffer_load_dwordx4 v18, s[12:15], s26 offen offset:0 lds
    buffer_load_dwordx4 v19, s[12:15], s26 offen offset:1024 lds
    buffer_load_dwordx4 v20, s[12:15], s26 offen offset:2048 lds
    buffer_load_dwordx4 v21, s[12:15], s26 offen offset:3072 lds
    s_mov_b32 m0, s31
    s_add_u32 s26, s26, 128
    buffer_load_dwordx4 v22, s[16:19], s27 offen offset:0 lds
    buffer_load_dwordx4 v23, s[16:19], s27 offen offset:1024 lds
    buffer_load_dwordx4 v24, s[16:19], s27 offen offset:2048 lds
    buffer_load_dwordx4 v25, s[16:19], s27 offen offset:3072 lds
    s_add_u32 s27, s27, 245760
    s_add_u32 s28, s28, 32768
    s_and_b32 s28, s28, 131071
    s_waitcnt vmcnt(16)
    s_barrier
    s_mov_b32 s25, 6
sequential_preLN__mha_block__glu_gated_geglu__prompt_kernel_ldloop:
    s_mov_b32 m0, s28
    s_add_u32 s31, s28, 16384
    buffer_load_dwordx4 v18, s[12:15], s26 offen offset:0 lds
    buffer_load_dwordx4 v19, s[12:15], s26 offen offset:1024 lds
    buffer_load_dwordx4 v20, s[12:15], s26 offen offset:2048 lds
    buffer_load_dwordx4 v21, s[12:15], s26 offen offset:3072 lds
    s_mov_b32 m0, s31
    s_add_u32 s26, s26, 128
    buffer_load_dwordx4 v22, s[16:19], s27 offen offset:0 lds
    buffer_load_dwordx4 v23, s[16:19], s27 offen offset:1024 lds
    buffer_load_dwordx4 v24, s[16:19], s27 offen offset:2048 lds
    buffer_load_dwordx4 v25, s[16:19], s27 offen offset:3072 lds
    s_add_u32 s27, s27, 245760
    s_add_u32 s28, s28, 32768
    s_and_b32 s28, s28, 131071
    s_waitcnt vmcnt(16)
    s_barrier
    s_sub_u32 s25, s25, 1
    s_cmp_lg_u32 s25, 0
    s_cbranch_scc1 sequential_preLN__mha_block__glu_gated_geglu__prompt_kernel_ldloop
    s_waitcnt lgkmcnt(0)
    s_and_b32 s58, s2, 31
    s_lshl_b32 s59, s20, 5
    s_add_u32 s58, s58, s59
    s_lshr_b32 s59, s2, 5
    s_mul_i32 s60, s58, 40960
    s_add_u32 s61, s58, 20
    s_mov_b32 s62, 8
    s_mov_b32 s63, 4
    s_mov_b32 s64, 0
    s_mov_b32 s65, 0
    s_mov_b32 s68, s56
    s_mov_b32 s69, s57
    s_mov_b32 s70, 1966080
    s_cmp_lt_u32 s58, 48
    s_cbranch_scc1 sequential_preLN__mha_block__glu_gated_geglu__prompt_kernel_job
    s_mov_b32 s68, s44
    s_mov_b32 s69, s45
    s_mov_b32 s70, 819200
    s_sub_u32 s61, s58, 48
    s_mul_i32 s60, s61, 51200
    s_lshr_b32 s65, s61, 3
    s_lshl_b32 s65, s65, 1
    s_add_u32 s61, s61, s65
    s_add_u32 s61, s61, 2
    s_mov_b32 s64, 4
    s_mov_b32 s65, 0
    s_cmp_lt_u32 s58, 64
    s_cbranch_scc1 sequential_preLN__mha_block__glu_gated_geglu__prompt_kernel_job
    s_sub_u32 s61, s58, 64
    s_mul_i32 s60, s61, 204800
    s_lshr_b32 s65, s61, 1
    s_lshl_b32 s65, s65, 3
    s_add_u32 s61, s61, s65
    s_mov_b32 s62, 40
    s_mov_b32 s63, 20
    s_mov_b32 s64, 0
    s_mov_b32 s65, 16
sequential_preLN__mha_block__glu_gated_geglu__prompt_kernel_job:
    s_and_b32 s69, s69, 0xffff
    s_mov_b32 s71, 0x20000
    s_mul_i32 s66, s59, 160
    s_add_u32 s60, s60, s66
    s_mul_i32 s61, s61, 5120
    s_mul_i32 s66, s59, 348160
    s_add_u32 s61, s61, s66
    s_add_u32 s61, s61, 19648512
    s_cmp_lt_u32 s58, 68
    s_cselect_b32 s60, s60, 1073741824
    s_cselect_b32 s61, s61, 1073741824
    s_mov_b32 s66, 6554
    v_add_u32 v2, 0, v0
    v_mul_u32_u24 v3, s66, v2
    v_lshrrev_b32 v3, 16, v3
    v_mul_u32_u24 v6, 10, v3
    v_sub_u32 v6, v2, v6
    v_bfe_u32 v8, v3, 2, 1
    v_bfe_u32 v9, v3, 3, 1
    v_and_b32 v7, 0x13, v3
    v_lshl_or_b32 v7, v8, 3, v7
    v_lshl_or_b32 v7, v9, 2, v7
    v_lshrrev_b32 v10, 3, v7
    v_mul_u32_u24 v10, s62, v10
    v_mad_u32_u24 v10, v9, s63, v10
    v_lshrrev_b32 v11, 4, v7
    v_mad_u32_u24 v10, v11, s64, v10
    v_and_b32 v11, 3, v7
    v_add3_u32 v10, v10, v11, s65
    v_mul_u32_u24 v10, 1280, v10
    v_lshl_add_u32 v84, v6, 4, v10
    v_add_u32 v2, 64, v0
    v_mul_u32_u24 v3, s66, v2
    v_lshrrev_b32 v3, 16, v3
    v_mul_u32_u24 v6, 10, v3
    v_sub_u32 v6, v2, v6
    v_bfe_u32 v8, v3, 2, 1
    v_bfe_u32 v9, v3, 3, 1
    v_and_b32 v7, 0x13, v3
    v_lshl_or_b32 v7, v8, 3, v7
    v_lshl_or_b32 v7, v9, 2, v7
    v_lshrrev_b32 v10, 3, v7
    v_mul_u32_u24 v10, s62, v10
    v_mad_u32_u24 v10, v9, s63, v10
    v_lshrrev_b32 v11, 4, v7
    v_mad_u32_u24 v10, v11, s64, v10
    v_and_b32 v11, 3, v7
    v_add3_u32 v10, v10, v11, s65
    v_mul_u32_u24 v10, 1280, v10
    v_lshl_add_u32 v85, v6, 4, v10
    v_add_u32 v2, 128, v0
    v_mul_u32_u24 v3, s66, v2
    v_lshrrev_b32 v3, 16, v3
    v_mul_u32_u24 v6, 10, v3
    v_sub_u32 v6, v2, v6
    v_bfe_u32 v8, v3, 2, 1
    v_bfe_u32 v9, v3, 3, 1
    v_and_b32 v7, 0x13, v3
    v_lshl_or_b32 v7, v8, 3, v7
    v_lshl_or_b32 v7, v9, 2, v7
    v_lshrrev_b32 v10, 3, v7
    v_mul_u32_u24 v10, s62, v10
    v_mad_u32_u24 v10, v9, s63, v10
    v_lshrrev_b32 v11, 4, v7
    v_mad_u32_u24 v10, v11, s64, v10
    v_and_b32 v11, 3, v7
    v_add3_u32 v10, v10, v11, s65
    v_mul_u32_u24 v10, 1280, v10
    v_lshl_add_u32 v86, v6, 4, v10
    v_add_u32 v2, 192, v0
    v_mul_u32_u24 v3, s66, v2
    v_lshrrev_b32 v3, 16, v3
    v_mul_u32_u24 v6, 10, v3
    v_sub_u32 v6, v2, v6
    v_bfe_u32 v8, v3, 2, 1
    v_bfe_u32 v9, v3, 3, 1
    v_and_b32 v7, 0x13, v3
    v_lshl_or_b32 v7, v8, 3, v7
    v_lshl_or_b32 v7, v9, 2, v7
    v_lshrrev_b32 v10, 3, v7
    v_mul_u32_u24 v10, s62, v10
    v_mad_u32_u24 v10, v9, s63, v10
    v_lshrrev_b32 v11, 4, v7
    v_mad_u32_u24 v10, v11, s64, v10
    v_and_b32 v11, 3, v7
    v_add3_u32 v10, v10, v11, s65
    v_mul_u32_u24 v10, 1280, v10
    v_lshl_add_u32 v87, v6, 4, v10
    v_add_u32 v2, 256, v0
    v_mul_u32_u24 v3, s66, v2
    v_lshrrev_b32 v3, 16, v3
    v_mul_u32_u24 v6, 10, v3
    v_sub_u32 v6, v2, v6
    v_bfe_u32 v8, v3, 2, 1
    v_bfe_u32 v9, v3, 3, 1
    v_and_b32 v7, 0x13, v3
    v_lshl_or_b32 v7, v8, 3, v7
    v_lshl_or_b32 v7, v9, 2, v7
    v_lshrrev_b32 v10, 3, v7
    v_mul_u32_u24 v10, s62, v10
    v_mad_u32_u24 v10, v9, s63, v10
    v_lshrrev_b32 v11, 4, v7
    v_mad_u32_u24 v10, v11, s64, v10
    v_and_b32 v11, 3, v7
    v_add3_u32 v10, v10, v11, s65
    v_mul_u32_u24 v10, 1280, v10
    v_lshl_add_u32 v88, v6, 4, v10
    s_mov_b32 s40, s44
    s_and_b32 s41, s45, 0xffff
    s_mov_b32 s42, 819200
    s_mov_b32 s43, 0x20000
    s_lshl_b32 s46, s2, 2
    s_add_u32 s46, s46, s20
    s_mul_i32 s47, s46, 1280
    v_cmp_gt_u32 vcc, 40, v0
    v_lshlrev_b32 v1, 5, v0
    v_mov_b32 v2, 1073741824
    v_cndmask_b32 v1, v2, v1, vcc
    s_waitcnt vmcnt(8)
    s_barrier
    buffer_load_dwordx4 v[64:67], v84, s[68:71], s60 offen
    buffer_load_dwordx4 v[68:71], v85, s[68:71], s60 offen
    buffer_load_dwordx4 v[72:75], v86, s[68:71], s60 offen
    buffer_load_dwordx4 v[76:79], v87, s[68:71], s60 offen
    buffer_load_dwordx4 v[80:83], v88, s[68:71], s60 offen
    buffer_load_dwordx4 v[32:35], v1, s[40:43], s47 offen
    buffer_load_dwordx4 v[36:39], v1, s[40:43], s47 offen offset:16
    s_waitcnt vmcnt(7)
    s_barrier
    s_barrier
    s_barrier
    s_mul_i32 s48, s46, 3277
    s_lshr_b32 s48, s48, 16
    s_mul_i32 s49, s48, 20
    s_sub_u32 s49, s46, s49
    s_lshr_b32 s50, s48, 4
    s_mul_i32 s50, s50, 1280
    s_and_b32 s51, s48, 1
    s_cmp_ge_u32 s49, 16
    s_cbranch_scc1 sequential_preLN__mha_block__glu_gated_geglu__prompt_kernel_tblrem
    s_bfe_u32 s52, s48, 0x30001
    s_add_u32 s52, s52, 2
    s_lshl_b32 s52, s52, 7
    s_lshl_b32 s51, s51, 6
    s_add_u32 s52, s52, s51
    s_lshr_b32 s51, s49, 3
    s_lshl_b32 s51, s51, 5
    s_add_u32 s52, s52, s51
    s_and_b32 s51, s49, 7
    s_branch sequential_preLN__mha_block__glu_gated_geglu__prompt_kernel_tbldone
sequential_preLN__mha_block__glu_gated_geglu__prompt_kernel_tblrem:
    s_bfe_u32 s52, s48, 0x10003
    s_lshl_b32 s52, s52, 7
    s_bfe_u32 s53, s48, 0x20001
    s_lshl_b32 s53, s53, 5
    s_add_u32 s52, s52, s53
    s_lshl_b32 s51, s51, 2
    s_add_u32 s51, s51, s49
    s_sub_u32 s51, s51, 16
sequential_preLN__mha_block__glu_gated_geglu__prompt_kernel_tbldone:
    s_lshl_b32 s51, s51, 1
    s_add_u32 s52, s52, s51
    s_add_u32 s52, s52, s50
    s_add_u32 s52, s52, 19480576
    s_cmp_lt_u32 s46, 640
    s_cselect_b32 s62, s52, 1073741824
    s_mul_i32 s66, s20, 5120
    s_add_u32 s66, s66, 135168
    v_lshlrev_b32 v1, 4, v0
    v_add_u32 v13, s66, v1
    v_bfe_u32 v10, v0, 2, 2
    v_bfe_u32 v11, v0, 4, 1
    v_lshl_add_u32 v10, v11, 2, v10
    v_lshrrev_b32 v11, 5, v0
    v_lshl_add_u32 v10, v11, 4, v10
    v_mul_u32_u24 v10, 160, v10
    v_and_b32 v11, 3, v0
    v_lshl_add_u32 v10, v11, 3, v10
    v_add_u32 v14, s66, v10
    s_waitcnt vmcnt(2)
    ds_write_b128 v13, v[64:67] offset:0
    ds_write_b128 v13, v[68:71] offset:1024
    ds_write_b128 v13, v[72:75] offset:2048
    ds_write_b128 v13, v[76:79] offset:3072
    ds_write_b128 v13, v[80:83] offset:4096
    s_waitcnt lgkmcnt(0)
    ds_read_b64_tr_b16 v[64:65], v14 offset:0
    ds_read_b64_tr_b16 v[66:67], v14 offset:1280
    ds_read_b64_tr_b16 v[68:69], v14 offset:32
    ds_read_b64_tr_b16 v[70:71], v14 offset:1312
    ds_read_b64_tr_b16 v[72:73], v14 offset:64
    ds_read_b64_tr_b16 v[74:75], v14 offset:1344
    ds_read_b64_tr_b16 v[76:77], v14 offset:96
    ds_read_b64_tr_b16 v[78:79], v14 offset:1376
    ds_read_b64_tr_b16 v[80:81], v14 offset:128
    ds_read_b64_tr_b16 v[82:83], v14 offset:1408
    s_waitcnt lgkmcnt(0)
    s_waitcnt vmcnt(0)
    v_lshlrev_b32 v40, 16, v32
    v_and_b32 v41, 0xffff0000, v32
    v_lshlrev_b32 v42, 16, v33
    v_and_b32 v43, 0xffff0000, v33
    v_lshlrev_b32 v44, 16, v34
    v_and_b32 v45, 0xffff0000, v34
    v_lshlrev_b32 v46, 16, v35
    v_and_b32 v47, 0xffff0000, v35
    v_lshlrev_b32 v48, 16, v36
    v_and_b32 v49, 0xffff0000, v36
    v_lshlrev_b32 v50, 16, v37
    v_and_b32 v51, 0xffff0000, v37
    v_lshlrev_b32 v52, 16, v38
    v_and_b32 v53, 0xffff0000, v38
    v_lshlrev_b32 v54, 16, v39
    v_and_b32 v55, 0xffff0000, v39
    v_add_f32 v40, v40, v48
    v_add_f32 v41, v41, v49
    v_add_f32 v42, v42, v50
    v_add_f32 v43, v43, v51
    v_add_f32 v44, v44, v52
    v_add_f32 v45, v45, v53
    v_add_f32 v46, v46, v54
    v_add_f32 v47, v47, v55
    v_add_f32 v40, v40, v44
    v_add_f32 v41, v41, v45
    v_add_f32 v42, v42, v46
    v_add_f32 v43, v43, v47
    v_add_f32 v40, v40, v42
    v_add_f32 v41, v41, v43
    v_add_f32 v40, v40, v41
    s_nop 1
    v_add_f32_dpp v40, v40, v40 row_shr:1 row_mask:0xf bank_mask:0xf bound_ctrl:1
    s_nop 1
    v_add_f32_dpp v40, v40, v40 row_shr:2 row_mask:0xf bank_mask:0xf bound_ctrl:1
    s_nop 1
    v_add_f32_dpp v40, v40, v40 row_shr:4 row_mask:0xf bank_mask:0xf bound_ctrl:1
    s_nop 1
    v_add_f32_dpp v40, v40, v40 row_shr:8 row_mask:0xf bank_mask:0xf bound_ctrl:1
    s_nop 1
    v_readlane_b32 s48, v40, 15
    v_readlane_b32 s49, v40, 31
    v_readlane_b32 s50, v40, 47
    s_nop 1
    v_mov_b32 v40, s48
    v_add_f32 v40, s49, v40
    v_add_f32 v40, s50, v40
    v_mul_f32 v40, 0x3acccccd, v40
    v_cvt_pk_bf16_f32 v41, v40, v40
    v_and_b32 v42, 0xffff0000, v41
    v_sub_f32 v42, v40, v42
    v_cvt_pk_bf16_f32 v42, v42, v42
    v_mov_b32 v43, 0
    s_branch sequential_preLN__mha_block__glu_gated_geglu__prompt_kernel_loader
sequential_preLN__mha_block__glu_gated_geglu__prompt_kernel_notloader:
    s_waitcnt lgkmcnt(0)
    s_mov_b32 s8, s4
    s_and_b32 s9, s5, 0xffff
    s_mov_b32 s10, 22433792
    s_mov_b32 s11, 0x20000
    s_cmp_ge_u32 s20, 4
    s_cbranch_scc1 sequential_preLN__mha_block__glu_gated_geglu__prompt_kernel_helpers
    s_cmp_eq_u32 s22, 15
    s_cbranch_scc1 sequential_preLN__mha_block__glu_gated_geglu__prompt_kernel_clear
    s_lshr_b32 s23, s20, 1
    s_and_b32 s24, s20, 1
    s_lshl_b32 s32, s23, 1
    s_add_u32 s32, s32, 0
    s_xor_b32 s31, s23, 0
    s_lshl_b32 s34, s24, 1
    s_add_u32 s34, s34, s31
    s_lshl_b32 s33, s23, 1
    s_add_u32 s33, s33, 1
    s_xor_b32 s31, s23, 1
    s_lshl_b32 s35, s24, 1
    s_add_u32 s35, s35, s31
    v_and_b32 v2, 31, v0
    v_lshrrev_b32 v3, 5, v0
    v_mov_b32 v7, v2
    s_cmp_ge_u32 s22, 10
    s_cbranch_scc0 sequential_preLN__mha_block__glu_gated_geglu__prompt_kernel_norowperm
    v_bfe_u32 v4, v0, 2, 1
    v_bfe_u32 v5, v0, 3, 1
    v_and_b32 v7, 0x13, v0
    v_lshl_or_b32 v7, v4, 3, v7
    v_lshl_or_b32 v7, v5, 2, v7
sequential_preLN__mha_block__glu_gated_geglu__prompt_kernel_norowperm:
    v_bfe_u32 v4, v7, 1, 3
    v_xor_b32 v4, v4, v3
    v_lshlrev_b32 v5, 7, v7
    v_xor_b32 v6, 0, v4
    v_lshl_add_u32 v6, v6, 4, v5
    s_lshl_b32 s31, s32, 12
    v_add_u32 v8, s31, v6
    s_lshl_b32 s31, s33, 12
    v_add_u32 v12, s31, v6
    v_xor_b32 v6, 2, v4
    v_lshl_add_u32 v6, v6, 4, v5
    s_lshl_b32 s31, s32, 12
    v_add_u32 v9, s31, v6
    s_lshl_b32 s31, s33, 12
    v_add_u32 v13, s31, v6
    v_xor_b32 v6, 4, v4
    v_lshl_add_u32 v6, v6, 4, v5
    s_lshl_b32 s31, s32, 12
    v_add_u32 v10, s31, v6
    s_lshl_b32 s31, s33, 12
    v_add_u32 v14, s31, v6
    v_xor_b32 v6, 6, v4
    v_lshl_add_u32 v6, v6, 4, v5
    s_lshl_b32 s31, s32, 12
    v_add_u32 v11, s31, v6
    s_lshl_b32 s31, s33, 12
    v_add_u32 v15, s31, v6
    v_bfe_u32 v4, v0, 2, 2
    v_lshl_add_u32 v5, v3, 3, v4
    v_lshlrev_b32 v5, 8, v5
    v_add_u32 v5, 16384, v5
    v_bfe_u32 v6, v0, 4, 1
    v_lshlrev_b32 v6, 1, v6
    v_lshl_add_u32 v6, v4, 2, v6
    v_and_b32 v26, 1, v0
    v_bfe_u32 v27, v0, 1, 1
    s_cmp_lt_u32 s34, 3
    s_cselect_b32 s31, 1, 0
    s_cmp_lt_u32 s22, 10
    s_cselect_b32 s31, s31, 0
    s_cmp_eq_u32 s31, 1
    s_cselect_b64 vcc, -1, 0
    s_lshl_b32 s31, s34, 2
    v_cndmask_b32 v28, v27, v26, vcc
    v_cndmask_b32 v29, v26, v27, vcc
    v_add3_u32 v28, v28, v6, s31
    v_and_b32 v28, 15, v28
    v_lshl_add_u32 v28, v28, 4, v5
    v_lshl_add_u32 v16, v29, 3, v28
    s_cmp_lt_u32 s35, 3
    s_cselect_b32 s31, 1, 0
    s_cmp_lt_u32 s22, 10
    s_cselect_b32 s31, s31, 0
    s_cmp_eq_u32 s31, 1
    s_cselect_b64 vcc, -1, 0
    s_lshl_b32 s31, s35, 2
    v_cndmask_b32 v28, v27, v26, vcc
    v_cndmask_b32 v29, v26, v27, vcc
    v_add3_u32 v28, v28, v6, s31
    v_and_b32 v28, 15, v28
    v_lshl_add_u32 v28, v28, 4, v5
    v_lshl_add_u32 v17, v29, 3, v28
    v_mov_b32 v64, 0
    v_mov_b32 v65, 0
    v_mov_b32 v66, 0
    v_mov_b32 v67, 0
    v_mov_b32 v68, 0
    v_mov_b32 v69, 0
    v_mov_b32 v70, 0
    v_mov_b32 v71, 0
    v_mov_b32 v72, 0
    v_mov_b32 v73, 0
    v_mov_b32 v74, 0
    v_mov_b32 v75, 0
    v_mov_b32 v76, 0
    v_mov_b32 v77, 0
    v_mov_b32 v78, 0
    v_mov_b32 v79, 0
    v_mov_b32 v80, 0
    v_mov_b32 v81, 0
    v_mov_b32 v82, 0
    v_mov_b32 v83, 0
    v_mov_b32 v84, 0
    v_mov_b32 v85, 0
    v_mov_b32 v86, 0
    v_mov_b32 v87, 0
    v_mov_b32 v88, 0
    v_mov_b32 v89, 0
    v_mov_b32 v90, 0
    v_mov_b32 v91, 0
    v_mov_b32 v92, 0
    v_mov_b32 v93, 0
    v_mov_b32 v94, 0
    v_mov_b32 v95, 0
    v_mov_b32 v96, 0
    v_mov_b32 v97, 0
    v_mov_b32 v98, 0
    v_mov_b32 v99, 0
    v_mov_b32 v100, 0
    v_mov_b32 v101, 0
    v_mov_b32 v102, 0
    v_mov_b32 v103, 0
    v_mov_b32 v104, 0
    v_mov_b32 v105, 0
    v_mov_b32 v106, 0
    v_mov_b32 v107, 0
    v_mov_b32 v108, 0
    v_mov_b32 v109, 0
    v_mov_b32 v110, 0
    v_mov_b32 v111, 0
    v_mov_b32 v112, 0
    v_mov_b32 v113, 0
    v_mov_b32 v114, 0
    v_mov_b32 v115, 0
    v_mov_b32 v116, 0
    v_mov_b32 v117, 0
    v_mov_b32 v118, 0
    v_mov_b32 v119, 0
    v_mov_b32 v120, 0
    v_mov_b32 v121, 0
    v_mov_b32 v122, 0
    v_mov_b32 v123, 0
    v_mov_b32 v124, 0
    v_mov_b32 v125, 0
    v_mov_b32 v126, 0
    v_mov_b32 v127, 0
    v_mov_b32 v128, 0
    v_mov_b32 v129, 0
    v_mov_b32 v130, 0
    v_mov_b32 v131, 0
    v_mov_b32 v132, 0x3f803f80
    v_mov_b32 v133, 0x3f803f80
    s_lshl_b32 s31, s21, 2
    s_add_u32 s32, s32, s31
    s_lshl_b32 s31, s21, 2
    s_add_u32 s33, s33, s31
    s_mov_b32 s25, 0
    s_mov_b32 s30, 0
    s_mov_b32 s38, 4294868992
    v_mov_b32 v18, 0
    v_mov_b32 v19, 0
    v_mov_b32 v20, 0
    v_mov_b32 v21, 0
    v_mov_b32 v22, 0
    v_mov_b32 v23, 0
    v_mov_b32 v24, 0
    v_mov_b32 v25, 0
    s_cmp_ge_u32 s22, 10
    s_cbranch_scc1 sequential_preLN__mha_block__glu_gated_geglu__prompt_kernel_noparam
    s_cmp_lt_u32 s22, 5
    s_cselect_b32 s44, 0x3ea52b5c, 1.0
    s_mov_b32 s39, 163840
    s_cselect_b32 s45, 81920, s39
    s_cselect_b32 s39, 0, 5
    s_cbranch_scc0 sequential_preLN__mha_block__glu_gated_geglu__prompt_kernel_pk
    s_mul_i32 s48, s32, 1280
    s_add_u32 s50, s48, 1024
    s_mul_i32 s49, s33, 1280
    s_add_u32 s51, s49, 1024
    s_branch sequential_preLN__mha_block__glu_gated_geglu__prompt_kernel_pd
sequential_preLN__mha_block__glu_gated_geglu__prompt_kernel_pk:
    s_lshr_b32 s40, s32, 3
    s_mul_i32 s40, s40, 20480
    s_add_u32 s40, s40, 2621440
    s_and_b32 s41, s32, 7
    s_lshl_b32 s42, s41, 10
    s_add_u32 s48, s40, s42
    s_lshl_b32 s42, s41, 8
    s_add_u32 s40, s40, s42
    s_add_u32 s50, s40, 8192
    s_lshr_b32 s40, s33, 3
    s_mul_i32 s40, s40, 20480
    s_add_u32 s40, s40, 2621440
    s_and_b32 s41, s33, 7
    s_lshl_b32 s42, s41, 10
    s_add_u32 s49, s40, s42
    s_lshl_b32 s42, s41, 8
    s_add_u32 s40, s40, s42
    s_add_u32 s51, s40, 8192
sequential_preLN__mha_block__glu_gated_geglu__prompt_kernel_pd:
    s_sub_u32 s39, s22, s39
    s_sub_u32 s46, 7, s39
    s_cmp_ge_u32 s46, 5
    s_cselect_b32 s3, 5, 0
    s_sub_u32 s46, s46, s3
    s_cmp_eq_u32 s46, 0
    s_cselect_b32 s47, 1, 0
    s_lshl_b32 s39, s39, 4
    v_lshlrev_b32 v4, 4, v2
    v_lshlrev_b32 v5, 3, v2
    v_mad_u32_u24 v5, v3, s45, v5
    v_lshl_add_u32 v6, v3, 3, v4
    s_movk_i32 s41, 205
    v_add_u32 v26, 0, v3
    v_cmp_le_u32 vcc, s46, v26
    s_mul_i32 s40, s34, 5
    s_add_u32 s40, s40, s39
    v_add_u32 v26, s40, v26
    v_addc_co_u32 v26, vcc, 0, v26, vcc
    v_mul_u32_u24 v27, s41, v26
    v_lshrrev_b32 v27, 10, v27
    v_mul_u32_u24 v28, 5, v27
    v_sub_u32 v28, v26, v28
    v_cmp_le_u32 vcc, 3, v28
    v_lshrrev_b32 v28, v28, 18
    v_and_b32 v28, 1, v28
    v_addc_co_u32 v27, vcc, v27, v27, vcc
    v_lshl_add_u32 v28, v28, 9, v4
    v_mad_u32_u24 v18, v27, s45, v28
    v_add_u32 v26, 2, v3
    v_cmp_le_u32 vcc, s46, v26
    s_mul_i32 s40, s34, 5
    s_add_u32 s40, s40, s39
    v_add_u32 v26, s40, v26
    v_addc_co_u32 v26, vcc, 0, v26, vcc
    v_mul_u32_u24 v27, s41, v26
    v_lshrrev_b32 v27, 10, v27
    v_mul_u32_u24 v28, 5, v27
    v_sub_u32 v28, v26, v28
    v_cmp_le_u32 vcc, 3, v28
    v_lshrrev_b32 v28, v28, 18
    v_and_b32 v28, 1, v28
    v_addc_co_u32 v27, vcc, v27, v27, vcc
    v_lshl_add_u32 v28, v28, 9, v4
    v_mad_u32_u24 v19, v27, s45, v28
    v_add_u32 v26, 0, v3
    v_cmp_le_u32 vcc, s46, v26
    s_mul_i32 s40, s35, 5
    s_add_u32 s40, s40, s39
    v_add_u32 v26, s40, v26
    v_addc_co_u32 v26, vcc, 0, v26, vcc
    v_mul_u32_u24 v27, s41, v26
    v_lshrrev_b32 v27, 10, v27
    v_mul_u32_u24 v28, 5, v27
    v_sub_u32 v28, v26, v28
    v_cmp_le_u32 vcc, 3, v28
    v_lshrrev_b32 v28, v28, 18
    v_and_b32 v28, 1, v28
    v_addc_co_u32 v27, vcc, v27, v27, vcc
    v_lshl_add_u32 v28, v28, 9, v4
    v_mad_u32_u24 v20, v27, s45, v28
    v_add_u32 v26, 2, v3
    v_cmp_le_u32 vcc, s46, v26
    s_mul_i32 s40, s35, 5
    s_add_u32 s40, s40, s39
    v_add_u32 v26, s40, v26
    v_addc_co_u32 v26, vcc, 0, v26, vcc
    v_mul_u32_u24 v27, s41, v26
    v_lshrrev_b32 v27, 10, v27
    v_mul_u32_u24 v28, 5, v27
    v_sub_u32 v28, v26, v28
    v_cmp_le_u32 vcc, 3, v28
    v_lshrrev_b32 v28, v28, 18
    v_and_b32 v28, 1, v28
    v_addc_co_u32 v27, vcc, v27, v27, vcc
    v_lshl_add_u32 v28, v28, 9, v4
    v_mad_u32_u24 v21, v27, s45, v28
    s_cmp_eq_u32 s47, 1
    s_cselect_b64 vcc, -1, 0
    s_cselect_b32 s52, s50, s48
    s_cselect_b32 s53, s51, s49
    v_cndmask_b32 v6, v6, v5, vcc
    s_add_u32 s40, s39, s46
    s_add_u32 s42, s40, 0
    v_mov_b32 v26, s42
    v_mul_u32_u24 v27, s41, v26
    v_lshrrev_b32 v27, 10, v27
    v_mul_u32_u24 v28, 5, v27
    v_sub_u32 v28, v26, v28
    v_cmp_le_u32 vcc, 3, v28
    v_lshrrev_b32 v28, v28, 18
    v_and_b32 v28, 1, v28
    v_addc_co_u32 v27, vcc, v27, v27, vcc
    v_lshl_add_u32 v28, v28, 9, v5
    v_mad_u32_u24 v22, v27, s45, v28
    s_add_u32 s42, s40, 5
    v_mov_b32 v26, s42
    v_mul_u32_u24 v27, s41, v26
    v_lshrrev_b32 v27, 10, v27
    v_mul_u32_u24 v28, 5, v27
    v_sub_u32 v28, v26, v28
    v_cmp_le_u32 vcc, 3, v28
    v_lshrrev_b32 v28, v28, 18
    v_and_b32 v28, 1, v28
    v_addc_co_u32 v27, vcc, v27, v27, vcc
    v_lshl_add_u32 v28, v28, 9, v5
    v_mad_u32_u24 v23, v27, s45, v28
    s_add_u32 s42, s40, 10
    v_mov_b32 v26, s42
    v_mul_u32_u24 v27, s41, v26
    v_lshrrev_b32 v27, 10, v27
    v_mul_u32_u24 v28, 5, v27
    v_sub_u32 v28, v26, v28
    v_cmp_le_u32 vcc, 3, v28
    v_lshrrev_b32 v28, v28, 18
    v_and_b32 v28, 1, v28
    v_addc_co_u32 v27, vcc, v27, v27, vcc
    v_lshl_add_u32 v28, v28, 9, v5
    v_mad_u32_u24 v24, v27, s45, v28
    s_add_u32 s42, s39, 15
    v_mov_b32 v26, s42
    v_mul_u32_u24 v27, s41, v26
    v_lshrrev_b32 v27, 10, v27
    v_mul_u32_u24 v28, 5, v27
    v_sub_u32 v28, v26, v28
    v_cmp_le_u32 vcc, 3, v28
    v_lshrrev_b32 v28, v28, 18
    v_and_b32 v28, 1, v28
    v_addc_co_u32 v27, vcc, v27, v27, vcc
    v_lshl_add_u32 v28, v28, 9, v6
    v_mad_u32_u24 v25, v27, s45, v28
sequential_preLN__mha_block__glu_gated_geglu__prompt_kernel_noparam:
    s_barrier
    ds_read_b128 v[32:35], v8
    ds_read_b128 v[36:39], v12
    ds_read_b64_tr_b16 v[40:41], v16 offset:0
    ds_read_b64_tr_b16 v[42:43], v16 offset:1024
    ds_read_b64_tr_b16 v[44:45], v17 offset:0
    ds_read_b64_tr_b16 v[46:47], v17 offset:1024
    s_cmp_ge_u32 s22, 10
    s_cbranch_scc1 sequential_preLN__mha_block__glu_gated_geglu__prompt_kernel_loopV
.p2align 3
sequential_preLN__mha_block__glu_gated_geglu__prompt_kernel_loopQ:
    s_waitcnt lgkmcnt(0)
    v_mfma_f32_32x32x16_bf16 v[64:79], v[40:43], v[32:35], v[64:79]
    ds_read_b128 v[48:51], v9
    ds_read_b128 v[52:55], v13
    ds_read_b64_tr_b16 v[56:57], v16 offset:4096
    ds_read_b64_tr_b16 v[58:59], v16 offset:5120
    v_mfma_f32_4x4x4bf16_1k v[128:131], v[132:133], v[40:41], v[128:131]
    v_mfma_f32_32x32x16_bf16 v[80:95], v[40:43], v[36:39], v[80:95]
    ds_read_b64_tr_b16 v[60:61], v17 offset:4096
    ds_read_b64_tr_b16 v[62:63], v17 offset:5120
    v_mfma_f32_4x4x4bf16_1k v[128:131], v[132:133], v[42:43], v[128:131]
    v_mfma_f32_32x32x16_bf16 v[96:111], v[44:47], v[32:35], v[96:111]
    v_mfma_f32_32x32x16_bf16 v[112:127], v[44:47], v[36:39], v[112:127]
    s_waitcnt lgkmcnt(0)
    v_mfma_f32_32x32x16_bf16 v[64:79], v[56:59], v[48:51], v[64:79]
    ds_read_b128 v[32:35], v10
    ds_read_b128 v[36:39], v14
    ds_read_b64_tr_b16 v[40:41], v16 offset:8192
    ds_read_b64_tr_b16 v[42:43], v16 offset:9216
    v_mfma_f32_4x4x4bf16_1k v[128:131], v[132:133], v[56:57], v[128:131]
    v_mfma_f32_32x32x16_bf16 v[80:95], v[56:59], v[52:55], v[80:95]
    ds_read_b64_tr_b16 v[44:45], v17 offset:8192
    ds_read_b64_tr_b16 v[46:47], v17 offset:9216
    v_mfma_f32_4x4x4bf16_1k v[128:131], v[132:133], v[58:59], v[128:131]
    v_mfma_f32_32x32x16_bf16 v[96:111], v[60:63], v[48:51], v[96:111]
    v_mfma_f32_32x32x16_bf16 v[112:127], v[60:63], v[52:55], v[112:127]
    s_waitcnt lgkmcnt(0)
    v_mfma_f32_32x32x16_bf16 v[64:79], v[40:43], v[32:35], v[64:79]
    ds_read_b128 v[48:51], v11
    ds_read_b128 v[52:55], v15
    ds_read_b64_tr_b16 v[56:57], v16 offset:12288
    ds_read_b64_tr_b16 v[58:59], v16 offset:13312
    v_mfma_f32_4x4x4bf16_1k v[128:131], v[132:133], v[40:41], v[128:131]
    v_mfma_f32_32x32x16_bf16 v[80:95], v[40:43], v[36:39], v[80:95]
    ds_read_b64_tr_b16 v[60:61], v17 offset:12288
    ds_read_b64_tr_b16 v[62:63], v17 offset:13312
    v_mfma_f32_4x4x4bf16_1k v[128:131], v[132:133], v[42:43], v[128:131]
    v_mfma_f32_32x32x16_bf16 v[96:111], v[44:47], v[32:35], v[96:111]
    v_mfma_f32_32x32x16_bf16 v[112:127], v[44:47], v[36:39], v[112:127]
    s_waitcnt lgkmcnt(0)
    s_barrier
    v_mfma_f32_32x32x16_bf16 v[64:79], v[56:59], v[48:51], v[64:79]
    s_add_u32 s30, s30, 32768
    s_cmp_eq_u32 s30, 131072
    s_cselect_b32 s29, s38, 32768
    s_cselect_b32 s30, 0, s30
    v_add_u32 v8, s29, v8
    v_add_u32 v12, s29, v12
    v_add_u32 v16, s29, v16
    v_add_u32 v17, s29, v17
    ds_read_b128 v[32:35], v8
    ds_read_b128 v[36:39], v12
    ds_read_b64_tr_b16 v[40:41], v16 offset:0
    ds_read_b64_tr_b16 v[42:43], v16 offset:1024
    v_mfma_f32_4x4x4bf16_1k v[128:131], v[132:133], v[56:57], v[128:131]
    v_mfma_f32_32x32x16_bf16 v[80:95], v[56:59], v[52:55], v[80:95]
    ds_read_b64_tr_b16 v[44:45], v17 offset:0
    ds_read_b64_tr_b16 v[46:47], v17 offset:1024
    v_mfma_f32_4x4x4bf16_1k v[128:131], v[132:133], v[58:59], v[128:131]
    v_mfma_f32_32x32x16_bf16 v[96:111], v[60:63], v[48:51], v[96:111]
    v_add_u32 v9, s29, v9
    v_add_u32 v10, s29, v10
    v_add_u32 v11, s29, v11
    v_add_u32 v13, s29, v13
    v_add_u32 v14, s29, v14
    v_add_u32 v15, s29, v15
    v_mfma_f32_32x32x16_bf16 v[112:127], v[60:63], v[52:55], v[112:127]
    s_add_u32 s25, s25, 1
    s_cmp_lt_u32 s25, 10
    s_cbranch_scc1 sequential_preLN__mha_block__glu_gated_geglu__prompt_kernel_loopQ
    s_lshl_b32 s31, s34, 7
    s_add_u32 s31, s31, 132608
    v_lshl_add_u32 v7, v2, 2, s31
    s_nop 1
    v_permlane32_swap_b32 v128, v129
    v_add_f32 v128, v128, v129
    ds_write_b32 v7, v128
    s_waitcnt lgkmcnt(0)
    s_barrier
    s_and_b32 s31, s32, 3
    s_lshl_b32 s31, s31, 7
    s_add_u32 s31, s31, 131072
    v_lshl_add_u32 v6, v2, 2, s31
    ds_read_b32 v26, v6
    ds_read_b32 v27, v6 offset:512
    s_and_b32 s31, s33, 3
    s_lshl_b32 s31, s31, 7
    s_add_u32 s31, s31, 131072
    v_lshl_add_u32 v6, v2, 2, s31
    ds_read_b32 v28, v6
    ds_read_b32 v29, v6 offset:512
    s_lshl_b32 s31, s34, 7
    s_add_u32 s31, s31, 132608
    v_lshl_add_u32 v7, v3, 4, s31
    ds_read_b128 v[136:139], v7 offset:0
    ds_read_b128 v[140:143], v7 offset:32
    ds_read_b128 v[144:147], v7 offset:64
    ds_read_b128 v[148:151], v7 offset:96
    s_lshl_b32 s31, s35, 7
    s_add_u32 s31, s31, 132608
    v_lshl_add_u32 v7, v3, 4, s31
    ds_read_b128 v[152:155], v7 offset:0
    ds_read_b128 v[156:159], v7 offset:32
    ds_read_b128 v[160:163], v7 offset:64
    ds_read_b128 v[164:167], v7 offset:96
    s_waitcnt lgkmcnt(8)
    v_mul_f32 v26, s44, v26
    v_mul_f32 v27, s44, v27
    v_mul_f32 v28, s44, v28
    v_mul_f32 v29, s44, v29
    s_waitcnt lgkmcnt(0)
    v_pk_mul_f32 v[64:65], v[64:65], v[26:27] op_sel_hi:[1,0]
    v_pk_fma_f32 v[64:65], v[136:137], v[26:27], v[64:65] op_sel:[0,1,0] op_sel_hi:[1,1,1] neg_lo:[0,1,0] neg_hi:[0,1,0]
    v_pk_mul_f32 v[66:67], v[66:67], v[26:27] op_sel_hi:[1,0]
    v_pk_fma_f32 v[66:67], v[138:139], v[26:27], v[66:67] op_sel:[0,1,0] op_sel_hi:[1,1,1] neg_lo:[0,1,0] neg_hi:[0,1,0]
    v_pk_mul_f32 v[68:69], v[68:69], v[26:27] op_sel_hi:[1,0]
    v_pk_fma_f32 v[68:69], v[140:141], v[26:27], v[68:69] op_sel:[0,1,0] op_sel_hi:[1,1,1] neg_lo:[0,1,0] neg_hi:[0,1,0]
    v_pk_mul_f32 v[70:71], v[70:71], v[26:27] op_sel_hi:[1,0]
    v_pk_fma_f32 v[70:71], v[142:143], v[26:27], v[70:71] op_sel:[0,1,0] op_sel_hi:[1,1,1] neg_lo:[0,1,0] neg_hi:[0,1,0]
    v_pk_mul_f32 v[72:73], v[72:73], v[26:27] op_sel_hi:[1,0]
    v_pk_fma_f32 v[72:73], v[144:145], v[26:27], v[72:73] op_sel:[0,1,0] op_sel_hi:[1,1,1] neg_lo:[0,1,0] neg_hi:[0,1,0]
    v_pk_mul_f32 v[74:75], v[74:75], v[26:27] op_sel_hi:[1,0]
    v_pk_fma_f32 v[74:75], v[146:147], v[26:27], v[74:75] op_sel:[0,1,0] op_sel_hi:[1,1,1] neg_lo:[0,1,0] neg_hi:[0,1,0]
    v_pk_mul_f32 v[76:77], v[76:77], v[26:27] op_sel_hi:[1,0]
    v_pk_fma_f32 v[76:77], v[148:149], v[26:27], v[76:77] op_sel:[0,1,0] op_sel_hi:[1,1,1] neg_lo:[0,1,0] neg_hi:[0,1,0]
    v_pk_mul_f32 v[78:79], v[78:79], v[26:27] op_sel_hi:[1,0]
    v_pk_fma_f32 v[78:79], v[150:151], v[26:27], v[78:79] op_sel:[0,1,0] op_sel_hi:[1,1,1] neg_lo:[0,1,0] neg_hi:[0,1,0]
    v_cvt_pk_bf16_f32 v64, v64, v65
    v_cvt_pk_bf16_f32 v65, v66, v67
    v_cvt_pk_bf16_f32 v66, v68, v69
    v_cvt_pk_bf16_f32 v67, v70, v71
    v_cvt_pk_bf16_f32 v68, v72, v73
    v_cvt_pk_bf16_f32 v69, v74, v75
    v_cvt_pk_bf16_f32 v70, v76, v77
    v_cvt_pk_bf16_f32 v71, v78, v79
    s_cmp_eq_u32 s34, 3
    s_cbranch_scc1 sequential_preLN__mha_block__glu_gated_geglu__prompt_kernel_rem00
    buffer_store_dwordx4 v[64:67], v18, s[8:11], s48 offen sc1
    buffer_store_dwordx4 v[68:71], v19, s[8:11], s48 offen sc1
    s_branch sequential_preLN__mha_block__glu_gated_geglu__prompt_kernel_std00
sequential_preLN__mha_block__glu_gated_geglu__prompt_kernel_rem00:
    buffer_store_dwordx2 v[64:65], v22, s[8:11], s50 offen sc1
    buffer_store_dwordx2 v[66:67], v23, s[8:11], s50 offen sc1
    buffer_store_dwordx2 v[68:69], v24, s[8:11], s50 offen sc1
    buffer_store_dwordx2 v[70:71], v25, s[8:11], s52 offen sc1
sequential_preLN__mha_block__glu_gated_geglu__prompt_kernel_std00:
    v_pk_mul_f32 v[80:81], v[80:81], v[28:29] op_sel_hi:[1,0]
    v_pk_fma_f32 v[80:81], v[136:137], v[28:29], v[80:81] op_sel:[0,1,0] op_sel_hi:[1,1,1] neg_lo:[0,1,0] neg_hi:[0,1,0]
    v_pk_mul_f32 v[82:83], v[82:83], v[28:29] op_sel_hi:[1,0]
    v_pk_fma_f32 v[82:83], v[138:139], v[28:29], v[82:83] op_sel:[0,1,0] op_sel_hi:[1,1,1] neg_lo:[0,1,0] neg_hi:[0,1,0]
    v_pk_mul_f32 v[84:85], v[84:85], v[28:29] op_sel_hi:[1,0]
    v_pk_fma_f32 v[84:85], v[140:141], v[28:29], v[84:85] op_sel:[0,1,0] op_sel_hi:[1,1,1] neg_lo:[0,1,0] neg_hi:[0,1,0]
    v_pk_mul_f32 v[86:87], v[86:87], v[28:29] op_sel_hi:[1,0]
    v_pk_fma_f32 v[86:87], v[142:143], v[28:29], v[86:87] op_sel:[0,1,0] op_sel_hi:[1,1,1] neg_lo:[0,1,0] neg_hi:[0,1,0]
    v_pk_mul_f32 v[88:89], v[88:89], v[28:29] op_sel_hi:[1,0]
    v_pk_fma_f32 v[88:89], v[144:145], v[28:29], v[88:89] op_sel:[0,1,0] op_sel_hi:[1,1,1] neg_lo:[0,1,0] neg_hi:[0,1,0]
    v_pk_mul_f32 v[90:91], v[90:91], v[28:29] op_sel_hi:[1,0]
    v_pk_fma_f32 v[90:91], v[146:147], v[28:29], v[90:91] op_sel:[0,1,0] op_sel_hi:[1,1,1] neg_lo:[0,1,0] neg_hi:[0,1,0]
    v_pk_mul_f32 v[92:93], v[92:93], v[28:29] op_sel_hi:[1,0]
    v_pk_fma_f32 v[92:93], v[148:149], v[28:29], v[92:93] op_sel:[0,1,0] op_sel_hi:[1,1,1] neg_lo:[0,1,0] neg_hi:[0,1,0]
    v_pk_mul_f32 v[94:95], v[94:95], v[28:29] op_sel_hi:[1,0]
    v_pk_fma_f32 v[94:95], v[150:151], v[28:29], v[94:95] op_sel:[0,1,0] op_sel_hi:[1,1,1] neg_lo:[0,1,0] neg_hi:[0,1,0]
    v_cvt_pk_bf16_f32 v80, v80, v81
    v_cvt_pk_bf16_f32 v81, v82, v83
    v_cvt_pk_bf16_f32 v82, v84, v85
    v_cvt_pk_bf16_f32 v83, v86, v87
    v_cvt_pk_bf16_f32 v84, v88, v89
    v_cvt_pk_bf16_f32 v85, v90, v91
    v_cvt_pk_bf16_f32 v86, v92, v93
    v_cvt_pk_bf16_f32 v87, v94, v95
    s_cmp_eq_u32 s34, 3
    s_cbranch_scc1 sequential_preLN__mha_block__glu_gated_geglu__prompt_kernel_rem01
    buffer_store_dwordx4 v[80:83], v18, s[8:11], s49 offen sc1
    buffer_store_dwordx4 v[84:87], v19, s[8:11], s49 offen sc1
    s_branch sequential_preLN__mha_block__glu_gated_geglu__prompt_kernel_std01
sequential_preLN__mha_block__glu_gated_geglu__prompt_kernel_rem01:
    buffer_store_dwordx2 v[80:81], v22, s[8:11], s51 offen sc1
    buffer_store_dwordx2 v[82:83], v23, s[8:11], s51 offen sc1
    buffer_store_dwordx2 v[84:85], v24, s[8:11], s51 offen sc1
    buffer_store_dwordx2 v[86:87], v25, s[8:11], s53 offen sc1
sequential_preLN__mha_block__glu_gated_geglu__prompt_kernel_std01:
    v_pk_mul_f32 v[96:97], v[96:97], v[26:27] op_sel_hi:[1,0]
    v_pk_fma_f32 v[96:97], v[152:153], v[26:27], v[96:97] op_sel:[0,1,0] op_sel_hi:[1,1,1] neg_lo:[0,1,0] neg_hi:[0,1,0]
    v_pk_mul_f32 v[98:99], v[98:99], v[26:27] op_sel_hi:[1,0]
    v_pk_fma_f32 v[98:99], v[154:155], v[26:27], v[98:99] op_sel:[0,1,0] op_sel_hi:[1,1,1] neg_lo:[0,1,0] neg_hi:[0,1,0]
    v_pk_mul_f32 v[100:101], v[100:101], v[26:27] op_sel_hi:[1,0]
    v_pk_fma_f32 v[100:101], v[156:157], v[26:27], v[100:101] op_sel:[0,1,0] op_sel_hi:[1,1,1] neg_lo:[0,1,0] neg_hi:[0,1,0]
    v_pk_mul_f32 v[102:103], v[102:103], v[26:27] op_sel_hi:[1,0]
    v_pk_fma_f32 v[102:103], v[158:159], v[26:27], v[102:103] op_sel:[0,1,0] op_sel_hi:[1,1,1] neg_lo:[0,1,0] neg_hi:[0,1,0]
    v_pk_mul_f32 v[104:105], v[104:105], v[26:27] op_sel_hi:[1,0]
    v_pk_fma_f32 v[104:105], v[160:161], v[26:27], v[104:105] op_sel:[0,1,0] op_sel_hi:[1,1,1] neg_lo:[0,1,0] neg_hi:[0,1,0]
    v_pk_mul_f32 v[106:107], v[106:107], v[26:27] op_sel_hi:[1,0]
    v_pk_fma_f32 v[106:107], v[162:163], v[26:27], v[106:107] op_sel:[0,1,0] op_sel_hi:[1,1,1] neg_lo:[0,1,0] neg_hi:[0,1,0]
    v_pk_mul_f32 v[108:109], v[108:109], v[26:27] op_sel_hi:[1,0]
    v_pk_fma_f32 v[108:109], v[164:165], v[26:27], v[108:109] op_sel:[0,1,0] op_sel_hi:[1,1,1] neg_lo:[0,1,0] neg_hi:[0,1,0]
    v_pk_mul_f32 v[110:111], v[110:111], v[26:27] op_sel_hi:[1,0]
    v_pk_fma_f32 v[110:111], v[166:167], v[26:27], v[110:111] op_sel:[0,1,0] op_sel_hi:[1,1,1] neg_lo:[0,1,0] neg_hi:[0,1,0]
    v_cvt_pk_bf16_f32 v96, v96, v97
    v_cvt_pk_bf16_f32 v97, v98, v99
    v_cvt_pk_bf16_f32 v98, v100, v101
    v_cvt_pk_bf16_f32 v99, v102, v103
    v_cvt_pk_bf16_f32 v100, v104, v105
    v_cvt_pk_bf16_f32 v101, v106, v107
    v_cvt_pk_bf16_f32 v102, v108, v109
    v_cvt_pk_bf16_f32 v103, v110, v111
    s_cmp_eq_u32 s35, 3
    s_cbranch_scc1 sequential_preLN__mha_block__glu_gated_geglu__prompt_kernel_rem10
    buffer_store_dwordx4 v[96:99], v20, s[8:11], s48 offen sc1
    buffer_store_dwordx4 v[100:103], v21, s[8:11], s48 offen sc1
    s_branch sequential_preLN__mha_block__glu_gated_geglu__prompt_kernel_std10
sequential_preLN__mha_block__glu_gated_geglu__prompt_kernel_rem10:
    buffer_store_dwordx2 v[96:97], v22, s[8:11], s50 offen sc1
    buffer_store_dwordx2 v[98:99], v23, s[8:11], s50 offen sc1
    buffer_store_dwordx2 v[100:101], v24, s[8:11], s50 offen sc1
    buffer_store_dwordx2 v[102:103], v25, s[8:11], s52 offen sc1
sequential_preLN__mha_block__glu_gated_geglu__prompt_kernel_std10:
    v_pk_mul_f32 v[112:113], v[112:113], v[28:29] op_sel_hi:[1,0]
    v_pk_fma_f32 v[112:113], v[152:153], v[28:29], v[112:113] op_sel:[0,1,0] op_sel_hi:[1,1,1] neg_lo:[0,1,0] neg_hi:[0,1,0]
    v_pk_mul_f32 v[114:115], v[114:115], v[28:29] op_sel_hi:[1,0]
    v_pk_fma_f32 v[114:115], v[154:155], v[28:29], v[114:115] op_sel:[0,1,0] op_sel_hi:[1,1,1] neg_lo:[0,1,0] neg_hi:[0,1,0]
    v_pk_mul_f32 v[116:117], v[116:117], v[28:29] op_sel_hi:[1,0]
    v_pk_fma_f32 v[116:117], v[156:157], v[28:29], v[116:117] op_sel:[0,1,0] op_sel_hi:[1,1,1] neg_lo:[0,1,0] neg_hi:[0,1,0]
    v_pk_mul_f32 v[118:119], v[118:119], v[28:29] op_sel_hi:[1,0]
    v_pk_fma_f32 v[118:119], v[158:159], v[28:29], v[118:119] op_sel:[0,1,0] op_sel_hi:[1,1,1] neg_lo:[0,1,0] neg_hi:[0,1,0]
    v_pk_mul_f32 v[120:121], v[120:121], v[28:29] op_sel_hi:[1,0]
    v_pk_fma_f32 v[120:121], v[160:161], v[28:29], v[120:121] op_sel:[0,1,0] op_sel_hi:[1,1,1] neg_lo:[0,1,0] neg_hi:[0,1,0]
    v_pk_mul_f32 v[122:123], v[122:123], v[28:29] op_sel_hi:[1,0]
    v_pk_fma_f32 v[122:123], v[162:163], v[28:29], v[122:123] op_sel:[0,1,0] op_sel_hi:[1,1,1] neg_lo:[0,1,0] neg_hi:[0,1,0]
    v_pk_mul_f32 v[124:125], v[124:125], v[28:29] op_sel_hi:[1,0]
    v_pk_fma_f32 v[124:125], v[164:165], v[28:29], v[124:125] op_sel:[0,1,0] op_sel_hi:[1,1,1] neg_lo:[0,1,0] neg_hi:[0,1,0]
    v_pk_mul_f32 v[126:127], v[126:127], v[28:29] op_sel_hi:[1,0]
    v_pk_fma_f32 v[126:127], v[166:167], v[28:29], v[126:127] op_sel:[0,1,0] op_sel_hi:[1,1,1] neg_lo:[0,1,0] neg_hi:[0,1,0]
    v_cvt_pk_bf16_f32 v112, v112, v113
    v_cvt_pk_bf16_f32 v113, v114, v115
    v_cvt_pk_bf16_f32 v114, v116, v117
    v_cvt_pk_bf16_f32 v115, v118, v119
    v_cvt_pk_bf16_f32 v116, v120, v121
    v_cvt_pk_bf16_f32 v117, v122, v123
    v_cvt_pk_bf16_f32 v118, v124, v125
    v_cvt_pk_bf16_f32 v119, v126, v127
    s_cmp_eq_u32 s35, 3
    s_cbranch_scc1 sequential_preLN__mha_block__glu_gated_geglu__prompt_kernel_rem11
    buffer_store_dwordx4 v[112:115], v20, s[8:11], s49 offen sc1
    buffer_store_dwordx4 v[116:119], v21, s[8:11], s49 offen sc1
    s_branch sequential_preLN__mha_block__glu_gated_geglu__prompt_kernel_std11
sequential_preLN__mha_block__glu_gated_geglu__prompt_kernel_rem11:
    buffer_store_dwordx2 v[112:113], v22, s[8:11], s51 offen sc1
    buffer_store_dwordx2 v[114:115], v23, s[8:11], s51 offen sc1
    buffer_store_dwordx2 v[116:117], v24, s[8:11], s51 offen sc1
    buffer_store_dwordx2 v[118:119], v25, s[8:11], s53 offen sc1
sequential_preLN__mha_block__glu_gated_geglu__prompt_kernel_std11:
    s_branch sequential_preLN__mha_block__glu_gated_geglu__prompt_kernel_p1done
.p2align 3
sequential_preLN__mha_block__glu_gated_geglu__prompt_kernel_loopV:
    s_waitcnt lgkmcnt(0)
    v_mfma_f32_32x32x16_bf16 v[64:79], v[32:35], v[40:43], v[64:79]
    ds_read_b128 v[48:51], v9
    ds_read_b128 v[52:55], v13
    ds_read_b64_tr_b16 v[56:57], v16 offset:4096
    ds_read_b64_tr_b16 v[58:59], v16 offset:5120
    v_mfma_f32_4x4x4bf16_1k v[128:131], v[132:133], v[40:41], v[128:131]
    v_mfma_f32_32x32x16_bf16 v[80:95], v[36:39], v[40:43], v[80:95]
    ds_read_b64_tr_b16 v[60:61], v17 offset:4096
    ds_read_b64_tr_b16 v[62:63], v17 offset:5120
    v_mfma_f32_4x4x4bf16_1k v[128:131], v[132:133], v[42:43], v[128:131]
    v_mfma_f32_32x32x16_bf16 v[96:111], v[32:35], v[44:47], v[96:111]
    v_mfma_f32_32x32x16_bf16 v[112:127], v[36:39], v[44:47], v[112:127]
    s_waitcnt lgkmcnt(0)
    v_mfma_f32_32x32x16_bf16 v[64:79], v[48:51], v[56:59], v[64:79]
    ds_read_b128 v[32:35], v10
    ds_read_b128 v[36:39], v14
    ds_read_b64_tr_b16 v[40:41], v16 offset:8192
    ds_read_b64_tr_b16 v[42:43], v16 offset:9216
    v_mfma_f32_4x4x4bf16_1k v[128:131], v[132:133], v[56:57], v[128:131]
    v_mfma_f32_32x32x16_bf16 v[80:95], v[52:55], v[56:59], v[80:95]
    ds_read_b64_tr_b16 v[44:45], v17 offset:8192
    ds_read_b64_tr_b16 v[46:47], v17 offset:9216
    v_mfma_f32_4x4x4bf16_1k v[128:131], v[132:133], v[58:59], v[128:131]
    v_mfma_f32_32x32x16_bf16 v[96:111], v[48:51], v[60:63], v[96:111]
    v_mfma_f32_32x32x16_bf16 v[112:127], v[52:55], v[60:63], v[112:127]
    s_waitcnt lgkmcnt(0)
    v_mfma_f32_32x32x16_bf16 v[64:79], v[32:35], v[40:43], v[64:79]
    ds_read_b128 v[48:51], v11
    ds_read_b128 v[52:55], v15
    ds_read_b64_tr_b16 v[56:57], v16 offset:12288
    ds_read_b64_tr_b16 v[58:59], v16 offset:13312
    v_mfma_f32_4x4x4bf16_1k v[128:131], v[132:133], v[40:41], v[128:131]
    v_mfma_f32_32x32x16_bf16 v[80:95], v[36:39], v[40:43], v[80:95]
    ds_read_b64_tr_b16 v[60:61], v17 offset:12288
    ds_read_b64_tr_b16 v[62:63], v17 offset:13312
    v_mfma_f32_4x4x4bf16_1k v[128:131], v[132:133], v[42:43], v[128:131]
    v_mfma_f32_32x32x16_bf16 v[96:111], v[32:35], v[44:47], v[96:111]
    v_mfma_f32_32x32x16_bf16 v[112:127], v[36:39], v[44:47], v[112:127]
    s_waitcnt lgkmcnt(0)
    s_barrier
    v_mfma_f32_32x32x16_bf16 v[64:79], v[48:51], v[56:59], v[64:79]
    s_add_u32 s30, s30, 32768
    s_cmp_eq_u32 s30, 131072
    s_cselect_b32 s29, s38, 32768
    s_cselect_b32 s30, 0, s30
    v_add_u32 v8, s29, v8
    v_add_u32 v12, s29, v12
    v_add_u32 v16, s29, v16
    v_add_u32 v17, s29, v17
    ds_read_b128 v[32:35], v8
    ds_read_b128 v[36:39], v12
    ds_read_b64_tr_b16 v[40:41], v16 offset:0
    ds_read_b64_tr_b16 v[42:43], v16 offset:1024
    v_mfma_f32_4x4x4bf16_1k v[128:131], v[132:133], v[56:57], v[128:131]
    v_mfma_f32_32x32x16_bf16 v[80:95], v[52:55], v[56:59], v[80:95]
    ds_read_b64_tr_b16 v[44:45], v17 offset:0
    ds_read_b64_tr_b16 v[46:47], v17 offset:1024
    v_mfma_f32_4x4x4bf16_1k v[128:131], v[132:133], v[58:59], v[128:131]
    v_mfma_f32_32x32x16_bf16 v[96:111], v[48:51], v[60:63], v[96:111]
    v_add_u32 v9, s29, v9
    v_add_u32 v10, s29, v10
    v_add_u32 v11, s29, v11
    v_add_u32 v13, s29, v13
    v_add_u32 v14, s29, v14
    v_add_u32 v15, s29, v15
    v_mfma_f32_32x32x16_bf16 v[112:127], v[52:55], v[60:63], v[112:127]
    s_add_u32 s25, s25, 1
    s_cmp_lt_u32 s25, 10
    s_cbranch_scc1 sequential_preLN__mha_block__glu_gated_geglu__prompt_kernel_loopV
    s_lshl_b32 s31, s34, 7
    s_add_u32 s31, s31, 132608
    v_lshl_add_u32 v7, v2, 2, s31
    s_nop 1
    v_permlane32_swap_b32 v128, v129
    v_add_f32 v128, v128, v129
    ds_write_b32 v7, v128
    s_waitcnt lgkmcnt(0)
    s_barrier
    s_and_b32 s31, s32, 3
    s_lshl_b32 s31, s31, 7
    s_add_u32 s31, s31, 131072
    v_lshl_add_u32 v6, v3, 5, s31
    ds_read_b128 v[32:35], v6 offset:0
    ds_read_b128 v[136:139], v6 offset:512
    ds_read_b128 v[36:39], v6 offset:16
    ds_read_b128 v[140:143], v6 offset:528
    ds_read_b128 v[40:43], v6 offset:64
    ds_read_b128 v[144:147], v6 offset:576
    ds_read_b128 v[44:47], v6 offset:80
    ds_read_b128 v[148:151], v6 offset:592
    s_waitcnt lgkmcnt(4)
    s_and_b32 s31, s33, 3
    s_lshl_b32 s31, s31, 7
    s_add_u32 s31, s31, 131072
    v_lshl_add_u32 v6, v3, 5, s31
    ds_read_b128 v[48:51], v6 offset:0
    ds_read_b128 v[152:155], v6 offset:512
    ds_read_b128 v[52:55], v6 offset:16
    ds_read_b128 v[156:159], v6 offset:528
    ds_read_b128 v[56:59], v6 offset:64
    ds_read_b128 v[160:163], v6 offset:576
    ds_read_b128 v[60:63], v6 offset:80
    ds_read_b128 v[164:167], v6 offset:592
    s_mov_b32 s40, 3277
    s_mov_b32 s41, 163200
    s_lshl_b32 s31, s34, 7
    s_add_u32 s31, s31, 132608
    v_lshl_add_u32 v7, v2, 2, s31
    ds_read_b32 v26, v7
    s_lshl_b32 s39, s22, 2
    s_add_u32 s39, s39, s34
    s_sub_u32 s39, s39, 40
    s_lshl_b32 s39, s39, 5
    v_add_u32 v4, s39, v2
    v_mul_u32_u24 v5, s40, v4
    v_lshrrev_b32 v5, 16, v5
    v_mul_u32_u24 v6, 20, v5
    v_sub_u32 v6, v4, v6
    v_bfe_u32 v6, v6, 3, 1
    v_xor_b32 v6, v6, v3
    v_lshlrev_b32 v4, 5, v4
    v_lshl_add_u32 v4, v6, 4, v4
    v_mad_u32_u24 v30, v5, s41, v4
    s_lshl_b32 s31, s35, 7
    s_add_u32 s31, s31, 132608
    v_lshl_add_u32 v7, v2, 2, s31
    ds_read_b32 v28, v7
    s_lshl_b32 s39, s22, 2
    s_add_u32 s39, s39, s35
    s_sub_u32 s39, s39, 40
    s_lshl_b32 s39, s39, 5
    v_add_u32 v4, s39, v2
    v_mul_u32_u24 v5, s40, v4
    v_lshrrev_b32 v5, 16, v5
    v_mul_u32_u24 v6, 20, v5
    v_sub_u32 v6, v4, v6
    v_bfe_u32 v6, v6, 3, 1
    v_xor_b32 v6, v6, v3
    v_lshlrev_b32 v4, 5, v4
    v_lshl_add_u32 v4, v6, 4, v4
    v_mad_u32_u24 v31, v5, s41, v4
    s_lshr_b32 s39, s32, 3
    s_mul_i32 s39, s39, 20480
    s_and_b32 s42, s32, 7
    s_mul_i32 s42, s42, 1280
    s_add_u32 s39, s39, s42
    s_add_u32 s44, s39, 2631680
    s_lshr_b32 s39, s33, 3
    s_mul_i32 s39, s39, 20480
    s_and_b32 s42, s33, 7
    s_mul_i32 s42, s42, 1280
    s_add_u32 s39, s39, s42
    s_add_u32 s45, s39, 2631680
    s_waitcnt lgkmcnt(0)
    v_pk_mul_f32 v[64:65], v[64:65], v[32:33]
    v_pk_fma_f32 v[64:65], v[136:137], v[26:27], v[64:65] op_sel_hi:[1,0,1] neg_lo:[1,0,0] neg_hi:[1,0,0]
    v_pk_mul_f32 v[66:67], v[66:67], v[34:35]
    v_pk_fma_f32 v[66:67], v[138:139], v[26:27], v[66:67] op_sel_hi:[1,0,1] neg_lo:[1,0,0] neg_hi:[1,0,0]
    v_pk_mul_f32 v[68:69], v[68:69], v[36:37]
    v_pk_fma_f32 v[68:69], v[140:141], v[26:27], v[68:69] op_sel_hi:[1,0,1] neg_lo:[1,0,0] neg_hi:[1,0,0]
    v_pk_mul_f32 v[70:71], v[70:71], v[38:39]
    v_pk_fma_f32 v[70:71], v[142:143], v[26:27], v[70:71] op_sel_hi:[1,0,1] neg_lo:[1,0,0] neg_hi:[1,0,0]
    v_pk_mul_f32 v[72:73], v[72:73], v[40:41]
    v_pk_fma_f32 v[72:73], v[144:145], v[26:27], v[72:73] op_sel_hi:[1,0,1] neg_lo:[1,0,0] neg_hi:[1,0,0]
    v_pk_mul_f32 v[74:75], v[74:75], v[42:43]
    v_pk_fma_f32 v[74:75], v[146:147], v[26:27], v[74:75] op_sel_hi:[1,0,1] neg_lo:[1,0,0] neg_hi:[1,0,0]
    v_pk_mul_f32 v[76:77], v[76:77], v[44:45]
    v_pk_fma_f32 v[76:77], v[148:149], v[26:27], v[76:77] op_sel_hi:[1,0,1] neg_lo:[1,0,0] neg_hi:[1,0,0]
    v_pk_mul_f32 v[78:79], v[78:79], v[46:47]
    v_pk_fma_f32 v[78:79], v[150:151], v[26:27], v[78:79] op_sel_hi:[1,0,1] neg_lo:[1,0,0] neg_hi:[1,0,0]
    v_cvt_pk_bf16_f32 v64, v64, v65
    v_cvt_pk_bf16_f32 v65, v66, v67
    v_cvt_pk_bf16_f32 v66, v68, v69
    v_cvt_pk_bf16_f32 v67, v70, v71
    v_cvt_pk_bf16_f32 v68, v72, v73
    v_cvt_pk_bf16_f32 v69, v74, v75
    v_cvt_pk_bf16_f32 v70, v76, v77
    v_cvt_pk_bf16_f32 v71, v78, v79
    buffer_store_dwordx4 v[64:67], v30, s[8:11], s44 offen sc1
    buffer_store_dwordx4 v[68:71], v30, s[8:11], s44 offen offset:640 sc1
    v_pk_mul_f32 v[80:81], v[80:81], v[48:49]
    v_pk_fma_f32 v[80:81], v[152:153], v[26:27], v[80:81] op_sel_hi:[1,0,1] neg_lo:[1,0,0] neg_hi:[1,0,0]
    v_pk_mul_f32 v[82:83], v[82:83], v[50:51]
    v_pk_fma_f32 v[82:83], v[154:155], v[26:27], v[82:83] op_sel_hi:[1,0,1] neg_lo:[1,0,0] neg_hi:[1,0,0]
    v_pk_mul_f32 v[84:85], v[84:85], v[52:53]
    v_pk_fma_f32 v[84:85], v[156:157], v[26:27], v[84:85] op_sel_hi:[1,0,1] neg_lo:[1,0,0] neg_hi:[1,0,0]
    v_pk_mul_f32 v[86:87], v[86:87], v[54:55]
    v_pk_fma_f32 v[86:87], v[158:159], v[26:27], v[86:87] op_sel_hi:[1,0,1] neg_lo:[1,0,0] neg_hi:[1,0,0]
    v_pk_mul_f32 v[88:89], v[88:89], v[56:57]
    v_pk_fma_f32 v[88:89], v[160:161], v[26:27], v[88:89] op_sel_hi:[1,0,1] neg_lo:[1,0,0] neg_hi:[1,0,0]
    v_pk_mul_f32 v[90:91], v[90:91], v[58:59]
    v_pk_fma_f32 v[90:91], v[162:163], v[26:27], v[90:91] op_sel_hi:[1,0,1] neg_lo:[1,0,0] neg_hi:[1,0,0]
    v_pk_mul_f32 v[92:93], v[92:93], v[60:61]
    v_pk_fma_f32 v[92:93], v[164:165], v[26:27], v[92:93] op_sel_hi:[1,0,1] neg_lo:[1,0,0] neg_hi:[1,0,0]
    v_pk_mul_f32 v[94:95], v[94:95], v[62:63]
    v_pk_fma_f32 v[94:95], v[166:167], v[26:27], v[94:95] op_sel_hi:[1,0,1] neg_lo:[1,0,0] neg_hi:[1,0,0]
    v_cvt_pk_bf16_f32 v80, v80, v81
    v_cvt_pk_bf16_f32 v81, v82, v83
    v_cvt_pk_bf16_f32 v82, v84, v85
    v_cvt_pk_bf16_f32 v83, v86, v87
    v_cvt_pk_bf16_f32 v84, v88, v89
    v_cvt_pk_bf16_f32 v85, v90, v91
    v_cvt_pk_bf16_f32 v86, v92, v93
    v_cvt_pk_bf16_f32 v87, v94, v95
    buffer_store_dwordx4 v[80:83], v30, s[8:11], s45 offen sc1
    buffer_store_dwordx4 v[84:87], v30, s[8:11], s45 offen offset:640 sc1
    v_pk_mul_f32 v[96:97], v[96:97], v[32:33]
    v_pk_fma_f32 v[96:97], v[136:137], v[28:29], v[96:97] op_sel_hi:[1,0,1] neg_lo:[1,0,0] neg_hi:[1,0,0]
    v_pk_mul_f32 v[98:99], v[98:99], v[34:35]
    v_pk_fma_f32 v[98:99], v[138:139], v[28:29], v[98:99] op_sel_hi:[1,0,1] neg_lo:[1,0,0] neg_hi:[1,0,0]
    v_pk_mul_f32 v[100:101], v[100:101], v[36:37]
    v_pk_fma_f32 v[100:101], v[140:141], v[28:29], v[100:101] op_sel_hi:[1,0,1] neg_lo:[1,0,0] neg_hi:[1,0,0]
    v_pk_mul_f32 v[102:103], v[102:103], v[38:39]
    v_pk_fma_f32 v[102:103], v[142:143], v[28:29], v[102:103] op_sel_hi:[1,0,1] neg_lo:[1,0,0] neg_hi:[1,0,0]
    v_pk_mul_f32 v[104:105], v[104:105], v[40:41]
    v_pk_fma_f32 v[104:105], v[144:145], v[28:29], v[104:105] op_sel_hi:[1,0,1] neg_lo:[1,0,0] neg_hi:[1,0,0]
    v_pk_mul_f32 v[106:107], v[106:107], v[42:43]
    v_pk_fma_f32 v[106:107], v[146:147], v[28:29], v[106:107] op_sel_hi:[1,0,1] neg_lo:[1,0,0] neg_hi:[1,0,0]
    v_pk_mul_f32 v[108:109], v[108:109], v[44:45]
    v_pk_fma_f32 v[108:109], v[148:149], v[28:29], v[108:109] op_sel_hi:[1,0,1] neg_lo:[1,0,0] neg_hi:[1,0,0]
    v_pk_mul_f32 v[110:111], v[110:111], v[46:47]
    v_pk_fma_f32 v[110:111], v[150:151], v[28:29], v[110:111] op_sel_hi:[1,0,1] neg_lo:[1,0,0] neg_hi:[1,0,0]
    v_cvt_pk_bf16_f32 v96, v96, v97
    v_cvt_pk_bf16_f32 v97, v98, v99
    v_cvt_pk_bf16_f32 v98, v100, v101
    v_cvt_pk_bf16_f32 v99, v102, v103
    v_cvt_pk_bf16_f32 v100, v104, v105
    v_cvt_pk_bf16_f32 v101, v106, v107
    v_cvt_pk_bf16_f32 v102, v108, v109
    v_cvt_pk_bf16_f32 v103, v110, v111
    buffer_store_dwordx4 v[96:99], v31, s[8:11], s44 offen sc1
    buffer_store_dwordx4 v[100:103], v31, s[8:11], s44 offen offset:640 sc1
    v_pk_mul_f32 v[112:113], v[112:113], v[48:49]
    v_pk_fma_f32 v[112:113], v[152:153], v[28:29], v[112:113] op_sel_hi:[1,0,1] neg_lo:[1,0,0] neg_hi:[1,0,0]
    v_pk_mul_f32 v[114:115], v[114:115], v[50:51]
    v_pk_fma_f32 v[114:115], v[154:155], v[28:29], v[114:115] op_sel_hi:[1,0,1] neg_lo:[1,0,0] neg_hi:[1,0,0]
    v_pk_mul_f32 v[116:117], v[116:117], v[52:53]
    v_pk_fma_f32 v[116:117], v[156:157], v[28:29], v[116:117] op_sel_hi:[1,0,1] neg_lo:[1,0,0] neg_hi:[1,0,0]
    v_pk_mul_f32 v[118:119], v[118:119], v[54:55]
    v_pk_fma_f32 v[118:119], v[158:159], v[28:29], v[118:119] op_sel_hi:[1,0,1] neg_lo:[1,0,0] neg_hi:[1,0,0]
    v_pk_mul_f32 v[120:121], v[120:121], v[56:57]
    v_pk_fma_f32 v[120:121], v[160:161], v[28:29], v[120:121] op_sel_hi:[1,0,1] neg_lo:[1,0,0] neg_hi:[1,0,0]
    v_pk_mul_f32 v[122:123], v[122:123], v[58:59]
    v_pk_fma_f32 v[122:123], v[162:163], v[28:29], v[122:123] op_sel_hi:[1,0,1] neg_lo:[1,0,0] neg_hi:[1,0,0]
    v_pk_mul_f32 v[124:125], v[124:125], v[60:61]
    v_pk_fma_f32 v[124:125], v[164:165], v[28:29], v[124:125] op_sel_hi:[1,0,1] neg_lo:[1,0,0] neg_hi:[1,0,0]
    v_pk_mul_f32 v[126:127], v[126:127], v[62:63]
    v_pk_fma_f32 v[126:127], v[166:167], v[28:29], v[126:127] op_sel_hi:[1,0,1] neg_lo:[1,0,0] neg_hi:[1,0,0]
    v_cvt_pk_bf16_f32 v112, v112, v113
    v_cvt_pk_bf16_f32 v113, v114, v115
    v_cvt_pk_bf16_f32 v114, v116, v117
    v_cvt_pk_bf16_f32 v115, v118, v119
    v_cvt_pk_bf16_f32 v116, v120, v121
    v_cvt_pk_bf16_f32 v117, v122, v123
    v_cvt_pk_bf16_f32 v118, v124, v125
    v_cvt_pk_bf16_f32 v119, v126, v127
    buffer_store_dwordx4 v[112:115], v31, s[8:11], s45 offen sc1
    buffer_store_dwordx4 v[116:119], v31, s[8:11], s45 offen offset:640 sc1
sequential_preLN__mha_block__glu_gated_geglu__prompt_kernel_p1done:
    s_setprio 0
    s_waitcnt vmcnt(0)
sequential_preLN__mha_block__glu_gated_geglu__prompt_kernel_p2_entry:
    s_load_dwordx2 s[70:71], s[0:1], 56
    s_and_b32 s6, s2, 7
    s_lshr_b32 s73, s2, 5
    s_lshl_b32 s72, s6, 2
    s_bfe_u32 s3, s2, 0x20003
    s_add_u32 s72, s72, s3
    s_and_b32 s74, s2, 6
    s_bfe_u32 s3, s2, 0x10003
    s_add_u32 s74, s74, s3
    s_and_b32 s75, s2, 1
    s_lshl_b32 s75, s75, 4
    s_lshr_b32 s3, s2, 4
    s_add_u32 s75, s75, s3
    s_and_b32 s21, s2, 7
    s_lshl_b32 s21, s21, 2
    s_bfe_u32 s27, s2, 0x20003
    s_add_u32 s21, s21, s27
    s_mul_i32 s25, s21, 163840
    s_add_u32 s25, s25, 2621440
    s_lshr_b32 s28, s2, 5
    s_lshl_b32 s28, s28, 3
    s_add_u32 s28, s28, s20
    s_mul_i32 s33, s21, 81920
    s_mul_i32 s32, s28, 1280
    s_add_u32 s33, s33, s32
    v_and_b32 v7, 31, v0
    v_lshlrev_b32 v9, 3, v7
    v_lshlrev_b32 v1, 4, v0
    s_add_u32 s32, s25, 8192
    v_lshlrev_b32 v3, 3, v0
    v_mov_b32 v2, v1
    v_lshrrev_b32 v11, 5, v0
    v_bfe_u32 v12, v0, 2, 1
    v_bfe_u32 v13, v0, 3, 1
    v_and_b32 v10, 0x13, v0
    v_lshl_or_b32 v10, v12, 3, v10
    v_lshl_or_b32 v10, v13, 2, v10
    v_xor_b32 v12, v11, v12
    v_lshlrev_b32 v10, 5, v10
    v_lshl_add_u32 v10, v12, 4, v10
    v_add_u32 v4, 10240, v10
    s_mov_b32 s34, 0xfffff
    s_mov_b32 s35, 0xfffff
    s_mov_b32 s36, 0x1100000
    s_mov_b32 s37, 0x1100000
    v_mov_b32 v6, 0xdddddddd
    v_mov_b32 v10, 0x3f803f80
    v_cndmask_b32 v10, 0, v10, s[36:37]
    v_mov_b32 v96, v10
    v_mov_b32 v97, v10
    v_mov_b32 v98, v10
    v_mov_b32 v99, v10
    v_mov_b32 v100, v10
    v_mov_b32 v101, v10
    v_mov_b32 v102, v10
    v_mov_b32 v103, v10
    v_mov_b32 v104, v10
    v_mov_b32 v105, v10
    v_mov_b32 v106, v10
    v_mov_b32 v107, v10
    v_mov_b32 v108, v10
    v_mov_b32 v109, v10
    v_mov_b32 v110, v10
    v_mov_b32 v111, v10
    v_mov_b32 v16, 0
    v_mov_b32 v17, 0
    v_mov_b32 v18, 0
    v_mov_b32 v19, 0
    v_mov_b32 v20, 0
    v_mov_b32 v21, 0
    v_mov_b32 v22, 0
    v_mov_b32 v23, 0
    v_mov_b32 v24, 0
    v_mov_b32 v25, 0
    v_mov_b32 v26, 0
    v_mov_b32 v27, 0
    v_mov_b32 v28, 0
    v_mov_b32 v29, 0
    v_mov_b32 v30, 0
    v_mov_b32 v31, 0
    v_mov_b32 v136, 0
    v_mov_b32 v137, 0
    v_mov_b32 v138, 0
    v_mov_b32 v139, 0
    v_mov_b32 v140, 0
    v_mov_b32 v141, 0
    v_mov_b32 v142, 0
    v_mov_b32 v143, 0
    s_waitcnt lgkmcnt(0)
    s_barrier
    s_barrier
    buffer_load_dwordx4 v[80:83], v1, s[8:11], s33 offen sc1
    buffer_load_dwordx2 v[84:85], v9, s[8:11], s33 offen offset:1024 sc1
    buffer_load_dwordx4 v[88:91], v1, s[8:11], s25 offen sc1
    buffer_load_dwordx2 v[92:93], v3, s[8:11], s32 offen sc1
    v_cmp_gt_u32 vcc, 32, v0
    s_nop 0
    s_waitcnt vmcnt(0)
    v_cndmask_b32 v86, v84, 0, vcc
    v_cndmask_b32 v87, v85, 0, vcc
    v_cndmask_b32 v84, 0, v84, vcc
    v_cndmask_b32 v85, 0, v85, vcc
    s_nop 0
    v_mfma_f32_32x32x16_bf16 v[48:63], v[88:91], v[80:83], 0
    v_mfma_f32_32x32x8bf16_1k v[48:63], v[92:93], v[84:85], v[48:63]
    s_nop 11
    v_max3_f32 v10, v48, v49, v50
    v_max3_f32 v11, v51, v52, v53
    v_max3_f32 v10, v10, v54, v55
    v_max3_f32 v11, v11, v56, v57
    v_max3_f32 v10, v10, v58, v59
    v_max3_f32 v11, v11, v60, v61
    v_max3_f32 v10, v10, v62, v63
    v_max_f32 v10, v10, v11
    v_mov_b32 v11, v10
    s_nop 1
    v_permlane32_swap_b32 v10, v11
    v_max_f32 v10, v10, v11
    v_sub_f32 v32, 0, v10
    v_sub_f32 v33, 0, v10
    v_sub_f32 v34, 0, v10
    v_sub_f32 v35, 0, v10
    v_sub_f32 v36, 0, v10
    v_sub_f32 v37, 0, v10
    v_sub_f32 v38, 0, v10
    v_sub_f32 v39, 0, v10
    v_sub_f32 v40, 0, v10
    v_sub_f32 v41, 0, v10
    v_sub_f32 v42, 0, v10
    v_sub_f32 v43, 0, v10
    v_sub_f32 v44, 0, v10
    v_sub_f32 v45, 0, v10
    v_sub_f32 v46, 0, v10
    v_sub_f32 v47, 0, v10
    v_sub_f32 v48, v48, v10
    v_sub_f32 v49, v49, v10
    v_sub_f32 v50, v50, v10
    v_sub_f32 v51, v51, v10
    v_sub_f32 v52, v52, v10
    v_sub_f32 v53, v53, v10
    v_sub_f32 v54, v54, v10
    v_sub_f32 v55, v55, v10
    v_sub_f32 v56, v56, v10
    v_sub_f32 v57, v57, v10
    v_sub_f32 v58, v58, v10
    v_sub_f32 v59, v59, v10
    v_sub_f32 v60, v60, v10
    v_sub_f32 v61, v61, v10
    v_sub_f32 v62, v62, v10
    v_sub_f32 v63, v63, v10
    s_barrier
    ds_read_b128 v[88:91], v2 offset:1024
    s_mov_b64 exec, s[34:35]
    ds_read_b128 v[96:99], v4 offset:0
    ds_read_b128 v[100:103], v4 offset:640
    s_mov_b64 exec, -1
    s_waitcnt lgkmcnt(2)
    v_mfma_f32_32x32x16_bf16 v[64:79], v[88:91], v[80:83], v[32:47]
    ds_read_b128 v[88:91], v2 offset:2048
    v_mfma_f32_32x32x8bf16_1k v[64:79], v[92:93], v[86:87], v[64:79]
    ds_read_b64 v[92:93], v3 offset:8704
    s_mov_b32 s22, 0
    s_cmp_lt_u32 s20, 4
    s_cselect_b32 s38, 0, 188
    s_lshl_b32 s39, s38, 1
    s_xor_b32 s39, s39, s38
    s_bitcmp0_b32 s38, 0
    s_cbranch_scc1 sequential_preLN__mha_block__glu_gated_geglu__prompt_kernel_prio
    s_setprio 1
sequential_preLN__mha_block__glu_gated_geglu__prompt_kernel_prio:
.p2align 3
sequential_preLN__mha_block__glu_gated_geglu__prompt_kernel_loop:
    v_exp_f32 v48, v48
    v_exp_f32 v49, v49
    v_smfmac_f32_32x32x32_bf16 v[16:31], v[108:111], v[136:143], v6
    s_mov_b64 exec, s[34:35]
    ds_read_b128 v[104:107], v4 offset:1280
    ds_read_b128 v[108:111], v4 offset:1920
    s_mov_b64 exec, -1
    v_exp_f32 v50, v50
    v_exp_f32 v51, v51
    v_exp_f32 v52, v52
    v_exp_f32 v53, v53
    s_waitcnt lgkmcnt(2)
    v_mfma_f32_32x32x16_bf16 v[112:127], v[88:91], v[80:83], v[32:47]
    ds_read_b128 v[88:91], v2 offset:3072
    v_exp_f32 v54, v54
    v_exp_f32 v55, v55
    v_exp_f32 v56, v56
    v_exp_f32 v57, v57
    v_mfma_f32_32x32x8bf16_1k v[112:127], v[92:93], v[84:85], v[112:127]
    v_exp_f32 v58, v58
    v_exp_f32 v59, v59
    v_exp_f32 v60, v60
    v_exp_f32 v61, v61
    v_smfmac_f32_32x32x32_bf16 v[16:31], v[96:99], v[48:55], v6
    v_exp_f32 v62, v62
    v_exp_f32 v63, v63
    v_exp_f32 v64, v64
    v_exp_f32 v65, v65
    v_smfmac_f32_32x32x32_bf16 v[16:31], v[100:103], v[56:63], v6
    s_mov_b64 exec, s[34:35]
    ds_read_b128 v[96:99], v4 offset:2560
    ds_read_b128 v[100:103], v4 offset:3200
    s_mov_b64 exec, -1
    v_exp_f32 v66, v66
    v_exp_f32 v67, v67
    v_exp_f32 v68, v68
    v_exp_f32 v69, v69
    s_waitcnt lgkmcnt(2)
    v_mfma_f32_32x32x16_bf16 v[128:143], v[88:91], v[80:83], v[32:47]
    ds_read_b128 v[88:91], v2 offset:4096
    v_exp_f32 v70, v70
    v_exp_f32 v71, v71
    v_exp_f32 v72, v72
    v_exp_f32 v73, v73
    v_mfma_f32_32x32x8bf16_1k v[128:143], v[92:93], v[86:87], v[128:143]
    ds_read_b64 v[92:93], v3 offset:9216
    v_exp_f32 v74, v74
    v_exp_f32 v75, v75
    v_exp_f32 v76, v76
    v_exp_f32 v77, v77
    v_smfmac_f32_32x32x32_bf16 v[16:31], v[104:107], v[64:71], v6
    v_exp_f32 v78, v78
    v_exp_f32 v79, v79
    v_exp_f32 v112, v112
    v_exp_f32 v113, v113
    v_smfmac_f32_32x32x32_bf16 v[16:31], v[108:111], v[72:79], v6
    s_mov_b64 exec, s[34:35]
    ds_read_b128 v[104:107], v4 offset:3840
    ds_read_b128 v[108:111], v4 offset:4480
    s_mov_b64 exec, -1
    v_exp_f32 v114, v114
    v_exp_f32 v115, v115
    v_exp_f32 v116, v116
    v_exp_f32 v117, v117
    s_waitcnt lgkmcnt(2)
    v_mfma_f32_32x32x16_bf16 v[48:63], v[88:91], v[80:83], v[32:47]
    ds_read_b128 v[88:91], v2 offset:5120
    v_exp_f32 v118, v118
    v_exp_f32 v119, v119
    v_exp_f32 v120, v120
    v_exp_f32 v121, v121
    v_mfma_f32_32x32x8bf16_1k v[48:63], v[92:93], v[84:85], v[48:63]
    v_exp_f32 v122, v122
    v_exp_f32 v123, v123
    v_exp_f32 v124, v124
    v_exp_f32 v125, v125
    v_smfmac_f32_32x32x32_bf16 v[16:31], v[96:99], v[112:119], v6
    v_exp_f32 v126, v126
    v_exp_f32 v127, v127
    v_exp_f32 v128, v128
    v_exp_f32 v129, v129
    v_smfmac_f32_32x32x32_bf16 v[16:31], v[100:103], v[120:127], v6
    s_mov_b64 exec, s[34:35]
    ds_read_b128 v[96:99], v4 offset:5120
    ds_read_b128 v[100:103], v4 offset:5760
    s_mov_b64 exec, -1
    v_exp_f32 v130, v130
    v_exp_f32 v131, v131
    v_exp_f32 v132, v132
    v_exp_f32 v133, v133
    s_waitcnt lgkmcnt(2)
    v_mfma_f32_32x32x16_bf16 v[64:79], v[88:91], v[80:83], v[32:47]
    ds_read_b128 v[88:91], v2 offset:6144
    v_exp_f32 v134, v134
    v_exp_f32 v135, v135
    v_exp_f32 v136, v136
    v_exp_f32 v137, v137
    v_mfma_f32_32x32x8bf16_1k v[64:79], v[92:93], v[86:87], v[64:79]
    ds_read_b64 v[92:93], v3 offset:9728
    v_exp_f32 v138, v138
    v_exp_f32 v139, v139
    v_exp_f32 v140, v140
    v_exp_f32 v141, v141
    v_smfmac_f32_32x32x32_bf16 v[16:31], v[104:107], v[128:135], v6
    v_exp_f32 v142, v142
    v_exp_f32 v143, v143
    v_exp_f32 v48, v48
    v_exp_f32 v49, v49
    v_smfmac_f32_32x32x32_bf16 v[16:31], v[108:111], v[136:143], v6
    s_mov_b64 exec, s[34:35]
    ds_read_b128 v[104:107], v4 offset:6400
    ds_read_b128 v[108:111], v4 offset:7040
    s_mov_b64 exec, -1
    v_exp_f32 v50, v50
    v_exp_f32 v51, v51
    v_exp_f32 v52, v52
    v_exp_f32 v53, v53
    s_waitcnt lgkmcnt(2)
    v_mfma_f32_32x32x16_bf16 v[112:127], v[88:91], v[80:83], v[32:47]
    ds_read_b128 v[88:91], v2 offset:7168
    v_exp_f32 v54, v54
    v_exp_f32 v55, v55
    v_exp_f32 v56, v56
    v_exp_f32 v57, v57
    v_mfma_f32_32x32x8bf16_1k v[112:127], v[92:93], v[84:85], v[112:127]
    v_exp_f32 v58, v58
    v_exp_f32 v59, v59
    v_exp_f32 v60, v60
    v_exp_f32 v61, v61
    v_smfmac_f32_32x32x32_bf16 v[16:31], v[96:99], v[48:55], v6
    v_exp_f32 v62, v62
    v_exp_f32 v63, v63
    v_exp_f32 v64, v64
    v_exp_f32 v65, v65
    v_smfmac_f32_32x32x32_bf16 v[16:31], v[100:103], v[56:63], v6
    s_mov_b64 exec, s[34:35]
    ds_read_b128 v[96:99], v4 offset:7680
    ds_read_b128 v[100:103], v4 offset:8320
    s_mov_b64 exec, -1
    v_exp_f32 v66, v66
    v_exp_f32 v67, v67
    v_exp_f32 v68, v68
    v_exp_f32 v69, v69
    s_waitcnt lgkmcnt(2)
    v_mfma_f32_32x32x16_bf16 v[128:143], v[88:91], v[80:83], v[32:47]
    s_bitcmp1_b32 65, s22
    s_cbranch_scc1 sequential_preLN__mha_block__glu_gated_geglu__prompt_kernel_bar
sequential_preLN__mha_block__glu_gated_geglu__prompt_kernel_barback:
    ds_read_b128 v[88:91], v2 offset:20480
    v_exp_f32 v70, v70
    v_exp_f32 v71, v71
    v_exp_f32 v72, v72
    v_exp_f32 v73, v73
    v_mfma_f32_32x32x8bf16_1k v[128:143], v[92:93], v[86:87], v[128:143]
    ds_read_b64 v[92:93], v3 offset:28672
    v_exp_f32 v74, v74
    v_exp_f32 v75, v75
    v_exp_f32 v76, v76
    v_exp_f32 v77, v77
    v_smfmac_f32_32x32x32_bf16 v[16:31], v[104:107], v[64:71], v6
    v_exp_f32 v78, v78
    v_exp_f32 v79, v79
    v_exp_f32 v112, v112
    v_exp_f32 v113, v113
    v_smfmac_f32_32x32x32_bf16 v[16:31], v[108:111], v[72:79], v6
    s_mov_b64 exec, s[34:35]
    ds_read_b128 v[104:107], v4 offset:8960
    ds_read_b128 v[108:111], v4 offset:9600
    s_mov_b64 exec, -1
    v_exp_f32 v114, v114
    v_exp_f32 v115, v115
    v_exp_f32 v116, v116
    v_exp_f32 v117, v117
    s_waitcnt lgkmcnt(2)
    v_mfma_f32_32x32x16_bf16 v[48:63], v[88:91], v[80:83], v[32:47]
    ds_read_b128 v[88:91], v2 offset:21504
    v_exp_f32 v118, v118
    v_exp_f32 v119, v119
    v_exp_f32 v120, v120
    v_exp_f32 v121, v121
    v_mfma_f32_32x32x8bf16_1k v[48:63], v[92:93], v[84:85], v[48:63]
    v_exp_f32 v122, v122
    v_exp_f32 v123, v123
    v_exp_f32 v124, v124
    v_exp_f32 v125, v125
    v_smfmac_f32_32x32x32_bf16 v[16:31], v[96:99], v[112:119], v6
    v_exp_f32 v126, v126
    v_exp_f32 v127, v127
    v_exp_f32 v128, v128
    v_exp_f32 v129, v129
    v_smfmac_f32_32x32x32_bf16 v[16:31], v[100:103], v[120:127], v6
    s_mov_b64 exec, s[34:35]
    ds_read_b128 v[96:99], v4 offset:20480
    ds_read_b128 v[100:103], v4 offset:21120
    s_mov_b64 exec, -1
    v_exp_f32 v130, v130
    v_exp_f32 v131, v131
    v_exp_f32 v132, v132
    v_exp_f32 v133, v133
    s_waitcnt lgkmcnt(2)
    v_mfma_f32_32x32x16_bf16 v[64:79], v[88:91], v[80:83], v[32:47]
    ds_read_b128 v[88:91], v2 offset:22528
    v_exp_f32 v134, v134
    v_exp_f32 v135, v135
    v_exp_f32 v136, v136
    v_exp_f32 v137, v137
    v_mfma_f32_32x32x8bf16_1k v[64:79], v[92:93], v[86:87], v[64:79]
    ds_read_b64 v[92:93], v3 offset:29184
    v_exp_f32 v138, v138
    v_exp_f32 v139, v139
    v_exp_f32 v140, v140
    v_exp_f32 v141, v141
    v_smfmac_f32_32x32x32_bf16 v[16:31], v[104:107], v[128:135], v6
    v_add_u32 v2, 20480, v2
    v_add_u32 v3, 20480, v3
    v_add_u32 v4, 20480, v4
    v_exp_f32 v142, v142
    v_exp_f32 v143, v143
    s_add_u32 s22, s22, 1
    s_bitcmp1_b32 s39, s22
    s_cbranch_scc1 sequential_preLN__mha_block__glu_gated_geglu__prompt_kernel_flip
sequential_preLN__mha_block__glu_gated_geglu__prompt_kernel_flipback:
    s_cmp_eq_u32 s22, 8
    s_cbranch_scc0 sequential_preLN__mha_block__glu_gated_geglu__prompt_kernel_loop
    v_smfmac_f32_32x32x32_bf16 v[16:31], v[108:111], v[136:143], v6
    s_waitcnt lgkmcnt(0)
    s_mul_i32 s33, s28, 40960
    s_mul_i32 s32, s21, 1280
    s_add_u32 s33, s33, s32
    s_add_u32 s33, s33, 7864320
    s_mov_b32 s36, 0x53800000
    v_cmp_gt_u32 s[38:39], 32, v0
    s_nop 5
    v_cndmask_b32 v12, v24, v28, s[38:39]
    v_mul_f32 v10, 0, v16
    v_mul_f32 v11, 0, v17
    v_fma_f32 v10, v18, 0, v10
    v_fma_f32 v11, v19, 0, v11
    v_fma_f32 v10, v20, 0, v10
    v_fma_f32 v11, v21, 0, v11
    v_fma_f32 v10, v22, 0, v10
    v_fma_f32 v11, v23, 0, v11
    v_fma_f32 v10, v24, 0, v10
    v_fma_f32 v11, v25, 0, v11
    v_fma_f32 v10, v26, 0, v10
    v_fma_f32 v11, v27, 0, v11
    v_add_f32 v10, v10, v11
    v_add_f32 v10, v10, v12
    v_cmp_nge_f32 vcc, s36, v10
    v_rcp_f32 v10, v12
    s_cbranch_vccnz sequential_preLN__mha_block__glu_gated_geglu__prompt_kernel_slow
sequential_preLN__mha_block__glu_gated_geglu__prompt_kernel_finish:
    v_pk_mul_f32 v[16:17], v[16:17], v[10:11] op_sel_hi:[1,0]
    v_pk_mul_f32 v[18:19], v[18:19], v[10:11] op_sel_hi:[1,0]
    v_pk_mul_f32 v[20:21], v[20:21], v[10:11] op_sel_hi:[1,0]
    v_pk_mul_f32 v[22:23], v[22:23], v[10:11] op_sel_hi:[1,0]
    v_pk_mul_f32 v[24:25], v[24:25], v[10:11] op_sel_hi:[1,0]
    v_pk_mul_f32 v[26:27], v[26:27], v[10:11] op_sel_hi:[1,0]
    v_cvt_pk_bf16_f32 v16, v16, v17
    v_cvt_pk_bf16_f32 v17, v18, v19
    v_cvt_pk_bf16_f32 v18, v20, v21
    v_cvt_pk_bf16_f32 v19, v22, v23
    v_cvt_pk_bf16_f32 v20, v24, v25
    v_cvt_pk_bf16_f32 v21, v26, v27
    buffer_store_dwordx4 v[16:19], v1, s[8:11], s33 offen sc1
    s_mov_b64 exec, 0xffffffff
    buffer_store_dwordx2 v[20:21], v9, s[8:11], s33 offen offset:1024 sc1
    s_mov_b64 exec, -1
    s_and_b32 s76, s20, 3
    s_lshr_b32 s77, s20, 2
    v_and_b32 v2, 15, v0
    v_lshrrev_b32 v3, 4, v0
    s_lshl_b32 s42, s72, 8
    s_lshl_b32 s43, s76, 6
    s_add_u32 s42, s42, s43
    s_lshl_b32 s49, s42, 1
    s_add_u32 s49, s49, 19464196
    v_lshlrev_b32 v14, 3, v2
    s_mul_i32 s43, s73, 8192
    s_add_u32 s46, s42, s43
    s_add_u32 s46, s46, 13107200
    s_mul_i32 s42, s77, 51200
    v_add_u32 v4, s42, v1
    s_mul_i32 s42, s77, 1280
    s_add_u32 s42, s42, 102400
    v_and_b32 v10, 1, v0
    v_lshlrev_b32 v10, 4, v10
    v_lshl_add_u32 v10, v3, 5, v10
    v_add_u32 v5, s42, v10
    v_lshrrev_b32 v10, 5, v0
    v_mul_u32_u24 v10, 1280, v10
    v_bfe_u32 v11, v0, 4, 1
    v_lshl_add_u32 v10, v11, 9, v10
    v_lshl_add_u32 v6, v2, 4, v10
    v_mul_u32_u24 v10, 2560, v3
    v_lshl_add_u32 v10, v2, 3, v10
    v_add_u32 v7, 1024, v10
    s_lshl_b32 s42, s76, 4
    v_add_u32 v10, s42, v2
    v_mul_u32_u24 v10, 160, v10
    v_lshl_add_u32 v10, v3, 3, v10
    v_add_u32 v8, 105472, v10
    s_lshl_b32 s42, s72, 1
    s_lshr_b32 s43, s76, 1
    s_add_u32 s47, s42, s43
    s_and_b32 s48, s76, 1
    s_mul_i32 s44, s47, 40960
    s_mul_i32 s43, s77, 20480
    s_add_u32 s44, s44, s43
    s_add_u32 s44, s44, 7864320
    s_lshl_b32 s43, s48, 7
    s_add_u32 s45, s44, s43
    s_add_u32 s44, s45, s43
    v_mov_b32 v16, 0
    v_mov_b32 v17, 0
    v_mov_b32 v18, 0
    v_mov_b32 v19, 0
    v_mov_b32 v20, 0
    v_mov_b32 v21, 0
    v_mov_b32 v22, 0
    v_mov_b32 v23, 0
    v_mov_b32 v24, 0
    v_mov_b32 v25, 0
    v_mov_b32 v26, 0
    v_mov_b32 v27, 0
    v_mov_b32 v28, 0
    v_mov_b32 v29, 0
    v_mov_b32 v30, 0
    v_mov_b32 v31, 0
    v_mov_b32 v32, 0
    v_mov_b32 v33, 0
    v_mov_b32 v34, 0
    v_mov_b32 v35, 0
    v_mov_b32 v36, 0
    v_mov_b32 v37, 0
    v_mov_b32 v38, 0
    v_mov_b32 v39, 0
    s_waitcnt vmcnt(0)
    s_barrier
    ds_read_b64 v[136:137], v8 offset:0
    ds_read_b64 v[138:139], v8 offset:32
    ds_read_b64 v[140:141], v8 offset:64
    ds_read_b64 v[142:143], v8 offset:96
    ds_read_b64 v[144:145], v8 offset:128
    s_cmp_eq_u32 s77, 0
    s_cbranch_scc1 sequential_preLN__mha_block__glu_gated_geglu__prompt_kernel_p3_prio
    s_setprio 1
sequential_preLN__mha_block__glu_gated_geglu__prompt_kernel_p3_prio:
    s_waitcnt lgkmcnt(0)
    s_barrier
    buffer_load_dwordx2 v[96:97], v7, s[8:11], s45 offen sc1
    buffer_load_dwordx2 v[98:99], v7, s[8:11], s45 offen offset:1280 sc1
    s_add_u32 s45, s45, 10240
    buffer_load_dwordx2 v[100:101], v7, s[8:11], s45 offen sc1
    buffer_load_dwordx2 v[102:103], v7, s[8:11], s45 offen offset:1280 sc1
    buffer_load_dwordx4 v[104:107], v6, s[8:11], s44 offen sc1
    s_add_u32 s44, s44, 2560
    buffer_load_dwordx4 v[108:111], v6, s[8:11], s44 offen sc1
    s_add_u32 s44, s44, 2560
    buffer_load_dword v13, v14, s[8:11], s49 offen sc1
    ds_read_b128 v[40:43], v4 offset:0
    ds_read_b128 v[44:47], v4 offset:1024
    ds_read_b128 v[48:51], v4 offset:2048
    ds_read_b128 v[52:55], v4 offset:3072
    ds_read_b128 v[56:59], v4 offset:4096
    ds_read_b128 v[60:63], v5 offset:0
    ds_read_b128 v[64:67], v4 offset:5120
    ds_read_b128 v[68:71], v4 offset:6144
    ds_read_b128 v[72:75], v4 offset:7168
    ds_read_b128 v[76:79], v4 offset:8192
    ds_read_b128 v[80:83], v4 offset:9216
    ds_read_b128 v[84:87], v5 offset:128
    s_waitcnt vmcnt(5)
    s_waitcnt lgkmcnt(9)
    v_mfma_f32_16x16x32_bf16 v[16:19], v[40:43], v[96:99], v[16:19]
    ds_read_b128 v[88:91], v4 offset:10240
    v_mfma_f32_16x16x32_bf16 v[20:23], v[44:47], v[96:99], v[20:23]
    ds_read_b128 v[40:43], v4 offset:11264
    buffer_load_dwordx4 v[112:115], v6, s[8:11], s44 offen sc1
    s_add_u32 s44, s44, 2560
    v_mfma_f32_16x16x32_bf16 v[24:27], v[48:51], v[96:99], v[24:27]
    ds_read_b128 v[44:47], v4 offset:12288
    s_waitcnt lgkmcnt(9)
    v_mfma_f32_16x16x32_bf16 v[28:31], v[52:55], v[96:99], v[28:31]
    ds_read_b128 v[48:51], v4 offset:13312
    v_mfma_f32_16x16x32_bf16 v[32:35], v[56:59], v[96:99], v[32:35]
    ds_read_b128 v[52:55], v4 offset:14336
    v_mfma_f32_16x16x32_bf16 v[36:39], v[60:63], v[96:99], v[36:39]
    ds_read_b128 v[56:59], v5 offset:256
    s_waitcnt vmcnt(4)
    s_waitcnt lgkmcnt(9)
    v_mfma_f32_16x16x32_bf16 v[16:19], v[64:67], v[100:103], v[16:19]
    ds_read_b128 v[60:63], v4 offset:15360
    v_mfma_f32_16x16x32_bf16 v[20:23], v[68:71], v[100:103], v[20:23]
    ds_read_b128 v[64:67], v4 offset:16384
    buffer_load_dwordx4 v[116:119], v6, s[8:11], s44 offen sc1
    s_add_u32 s44, s44, 2560
    v_mfma_f32_16x16x32_bf16 v[24:27], v[72:75], v[100:103], v[24:27]
    ds_read_b128 v[68:71], v4 offset:17408
    s_waitcnt lgkmcnt(9)
    v_mfma_f32_16x16x32_bf16 v[28:31], v[76:79], v[100:103], v[28:31]
    ds_read_b128 v[72:75], v4 offset:18432
    v_mfma_f32_16x16x32_bf16 v[32:35], v[80:83], v[100:103], v[32:35]
    ds_read_b128 v[76:79], v4 offset:19456
    v_mfma_f32_16x16x32_bf16 v[36:39], v[84:87], v[100:103], v[36:39]
    ds_read_b128 v[80:83], v5 offset:384
    s_waitcnt vmcnt(4)
    s_waitcnt lgkmcnt(9)
    v_mfma_f32_16x16x32_bf16 v[16:19], v[88:91], v[104:107], v[16:19]
    ds_read_b128 v[84:87], v4 offset:20480
    v_mfma_f32_16x16x32_bf16 v[20:23], v[40:43], v[104:107], v[20:23]
    ds_read_b128 v[88:91], v4 offset:21504
    buffer_load_dwordx4 v[120:123], v6, s[8:11], s44 offen sc1
    s_add_u32 s44, s44, 2560
    v_mfma_f32_16x16x32_bf16 v[24:27], v[44:47], v[104:107], v[24:27]
    ds_read_b128 v[40:43], v4 offset:22528
    s_waitcnt lgkmcnt(9)
    v_mfma_f32_16x16x32_bf16 v[28:31], v[48:51], v[104:107], v[28:31]
    ds_read_b128 v[44:47], v4 offset:23552
    v_mfma_f32_16x16x32_bf16 v[32:35], v[52:55], v[104:107], v[32:35]
    ds_read_b128 v[48:51], v4 offset:24576
    v_mfma_f32_16x16x32_bf16 v[36:39], v[56:59], v[104:107], v[36:39]
    ds_read_b128 v[52:55], v5 offset:512
    s_waitcnt vmcnt(4)
    s_waitcnt lgkmcnt(9)
    v_mfma_f32_16x16x32_bf16 v[16:19], v[60:63], v[108:111], v[16:19]
    ds_read_b128 v[56:59], v4 offset:25600
    v_mfma_f32_16x16x32_bf16 v[20:23], v[64:67], v[108:111], v[20:23]
    ds_read_b128 v[60:63], v4 offset:26624
    buffer_load_dwordx4 v[124:127], v6, s[8:11], s44 offen sc1
    s_add_u32 s44, s44, 2560
    v_mfma_f32_16x16x32_bf16 v[24:27], v[68:71], v[108:111], v[24:27]
    ds_read_b128 v[64:67], v4 offset:27648
    s_waitcnt lgkmcnt(9)
    v_mfma_f32_16x16x32_bf16 v[28:31], v[72:75], v[108:111], v[28:31]
    ds_read_b128 v[68:71], v4 offset:28672
    v_mfma_f32_16x16x32_bf16 v[32:35], v[76:79], v[108:111], v[32:35]
    ds_read_b128 v[72:75], v4 offset:29696
    v_mfma_f32_16x16x32_bf16 v[36:39], v[80:83], v[108:111], v[36:39]
    ds_read_b128 v[76:79], v5 offset:640
    s_waitcnt vmcnt(3)
    s_waitcnt lgkmcnt(9)
    v_mfma_f32_16x16x32_bf16 v[16:19], v[84:87], v[112:115], v[16:19]
    ds_read_b128 v[80:83], v4 offset:30720
    v_mfma_f32_16x16x32_bf16 v[20:23], v[88:91], v[112:115], v[20:23]
    ds_read_b128 v[84:87], v4 offset:31744
    buffer_load_dwordx4 v[128:131], v6, s[8:11], s44 offen sc1
    s_add_u32 s44, s44, 2560
    v_mfma_f32_16x16x32_bf16 v[24:27], v[40:43], v[112:115], v[24:27]
    ds_read_b128 v[88:91], v4 offset:32768
    s_waitcnt lgkmcnt(9)
    v_mfma_f32_16x16x32_bf16 v[28:31], v[44:47], v[112:115], v[28:31]
    ds_read_b128 v[40:43], v4 offset:33792
    v_mfma_f32_16x16x32_bf16 v[32:35], v[48:51], v[112:115], v[32:35]
    ds_read_b128 v[44:47], v4 offset:34816
    v_mfma_f32_16x16x32_bf16 v[36:39], v[52:55], v[112:115], v[36:39]
    ds_read_b128 v[48:51], v5 offset:768
    s_waitcnt vmcnt(3)
    s_waitcnt lgkmcnt(9)
    v_mfma_f32_16x16x32_bf16 v[16:19], v[56:59], v[116:119], v[16:19]
    ds_read_b128 v[52:55], v4 offset:35840
    v_mfma_f32_16x16x32_bf16 v[20:23], v[60:63], v[116:119], v[20:23]
    ds_read_b128 v[56:59], v4 offset:36864
    buffer_load_dwordx4 v[132:135], v6, s[8:11], s44 offen sc1
    s_add_u32 s44, s44, 2560
    v_mfma_f32_16x16x32_bf16 v[24:27], v[64:67], v[116:119], v[24:27]
    ds_read_b128 v[60:63], v4 offset:37888
    s_waitcnt lgkmcnt(9)
    v_mfma_f32_16x16x32_bf16 v[28:31], v[68:71], v[116:119], v[28:31]
    ds_read_b128 v[64:67], v4 offset:38912
    v_mfma_f32_16x16x32_bf16 v[32:35], v[72:75], v[116:119], v[32:35]
    ds_read_b128 v[68:71], v4 offset:39936
    v_mfma_f32_16x16x32_bf16 v[36:39], v[76:79], v[116:119], v[36:39]
    ds_read_b128 v[72:75], v5 offset:896
    s_waitcnt vmcnt(3)
    s_waitcnt lgkmcnt(9)
    v_mfma_f32_16x16x32_bf16 v[16:19], v[80:83], v[120:123], v[16:19]
    ds_read_b128 v[76:79], v4 offset:40960
    v_mfma_f32_16x16x32_bf16 v[20:23], v[84:87], v[120:123], v[20:23]
    ds_read_b128 v[80:83], v4 offset:41984
    v_mfma_f32_16x16x32_bf16 v[24:27], v[88:91], v[120:123], v[24:27]
    ds_read_b128 v[84:87], v4 offset:43008
    s_waitcnt lgkmcnt(9)
    v_mfma_f32_16x16x32_bf16 v[28:31], v[40:43], v[120:123], v[28:31]
    ds_read_b128 v[88:91], v4 offset:44032
    v_mfma_f32_16x16x32_bf16 v[32:35], v[44:47], v[120:123], v[32:35]
    ds_read_b128 v[40:43], v4 offset:45056
    v_mfma_f32_16x16x32_bf16 v[36:39], v[48:51], v[120:123], v[36:39]
    ds_read_b128 v[44:47], v5 offset:1024
    s_waitcnt vmcnt(2)
    s_waitcnt lgkmcnt(9)
    v_mfma_f32_16x16x32_bf16 v[16:19], v[52:55], v[124:127], v[16:19]
    ds_read_b128 v[48:51], v4 offset:46080
    v_mfma_f32_16x16x32_bf16 v[20:23], v[56:59], v[124:127], v[20:23]
    ds_read_b128 v[52:55], v4 offset:47104
    v_mfma_f32_16x16x32_bf16 v[24:27], v[60:63], v[124:127], v[24:27]
    ds_read_b128 v[56:59], v4 offset:48128
    s_waitcnt lgkmcnt(9)
    v_mfma_f32_16x16x32_bf16 v[28:31], v[64:67], v[124:127], v[28:31]
    ds_read_b128 v[60:63], v4 offset:49152
    v_mfma_f32_16x16x32_bf16 v[32:35], v[68:71], v[124:127], v[32:35]
    ds_read_b128 v[64:67], v4 offset:50176
    v_mfma_f32_16x16x32_bf16 v[36:39], v[72:75], v[124:127], v[36:39]
    ds_read_b128 v[68:71], v5 offset:1152
    s_waitcnt vmcnt(1)
    s_waitcnt lgkmcnt(9)
    v_mfma_f32_16x16x32_bf16 v[16:19], v[76:79], v[128:131], v[16:19]
    v_mfma_f32_16x16x32_bf16 v[20:23], v[80:83], v[128:131], v[20:23]
    v_mfma_f32_16x16x32_bf16 v[24:27], v[84:87], v[128:131], v[24:27]
    s_waitcnt lgkmcnt(6)
    v_mfma_f32_16x16x32_bf16 v[28:31], v[88:91], v[128:131], v[28:31]
    v_mfma_f32_16x16x32_bf16 v[32:35], v[40:43], v[128:131], v[32:35]
    v_mfma_f32_16x16x32_bf16 v[36:39], v[44:47], v[128:131], v[36:39]
    s_waitcnt vmcnt(0)
    s_waitcnt lgkmcnt(3)
    v_mfma_f32_16x16x32_bf16 v[16:19], v[48:51], v[132:135], v[16:19]
    v_mfma_f32_16x16x32_bf16 v[20:23], v[52:55], v[132:135], v[20:23]
    v_mfma_f32_16x16x32_bf16 v[24:27], v[56:59], v[132:135], v[24:27]
    s_waitcnt lgkmcnt(0)
    v_mfma_f32_16x16x32_bf16 v[28:31], v[60:63], v[132:135], v[28:31]
    v_mfma_f32_16x16x32_bf16 v[32:35], v[64:67], v[132:135], v[32:35]
    v_mfma_f32_16x16x32_bf16 v[36:39], v[68:71], v[132:135], v[36:39]
    s_mul_i32 s42, s76, 5376
    s_add_u32 s42, s42, 105472
    v_lshl_add_u32 v10, v0, 4, s42
    v_lshl_add_u32 v4, v0, 2, s42
    s_cmp_eq_u32 s77, 0
    s_cbranch_scc1 sequential_preLN__mha_block__glu_gated_geglu__prompt_kernel_p3_fin
    s_nop 1
    ds_write_b128 v10, v[16:19] offset:0
    ds_write_b128 v10, v[20:23] offset:1024
    ds_write_b128 v10, v[24:27] offset:2048
    ds_write_b128 v10, v[28:31] offset:3072
    ds_write_b128 v10, v[32:35] offset:4096
    v_add_f32 v11, v36, v37
    ds_write_b32 v4, v11 offset:5120
    s_waitcnt lgkmcnt(0)
    s_barrier
    s_branch sequential_preLN__mha_block__glu_gated_geglu__prompt_kernel_p3_done
sequential_preLN__mha_block__glu_gated_geglu__prompt_kernel_p3_fin:
    v_lshlrev_b32 v148, 16, v136
    v_and_b32 v149, 0xffff0000, v136
    v_lshlrev_b32 v150, 16, v137
    v_and_b32 v151, 0xffff0000, v137
    v_lshlrev_b32 v152, 16, v138
    v_and_b32 v153, 0xffff0000, v138
    v_lshlrev_b32 v154, 16, v139
    v_and_b32 v155, 0xffff0000, v139
    v_lshlrev_b32 v156, 16, v140
    v_and_b32 v157, 0xffff0000, v140
    v_lshlrev_b32 v158, 16, v141
    v_and_b32 v159, 0xffff0000, v141
    v_lshlrev_b32 v160, 16, v142
    v_and_b32 v161, 0xffff0000, v142
    v_lshlrev_b32 v162, 16, v143
    v_and_b32 v163, 0xffff0000, v143
    v_lshlrev_b32 v164, 16, v144
    v_and_b32 v165, 0xffff0000, v144
    v_lshlrev_b32 v166, 16, v145
    v_and_b32 v167, 0xffff0000, v145
    v_pk_add_f32 v[148:149], v[148:149], v[16:17]
    v_pk_add_f32 v[150:151], v[150:151], v[18:19]
    v_pk_add_f32 v[152:153], v[152:153], v[20:21]
    v_pk_add_f32 v[154:155], v[154:155], v[22:23]
    v_pk_add_f32 v[156:157], v[156:157], v[24:25]
    v_pk_add_f32 v[158:159], v[158:159], v[26:27]
    v_pk_add_f32 v[160:161], v[160:161], v[28:29]
    v_pk_add_f32 v[162:163], v[162:163], v[30:31]
    v_pk_add_f32 v[164:165], v[164:165], v[32:33]
    v_pk_add_f32 v[166:167], v[166:167], v[34:35]
    v_add_f32 v13, v13, v36
    v_add_f32 v13, v13, v37
    v_lshrrev_b32 v11, 1, v3
    v_lshlrev_b32 v11, 9, v11
    v_lshl_add_u32 v15, v2, 4, v11
    v_and_b32 v11, 1, v3
    v_lshl_add_u32 v12, v11, 10, v15
    s_mul_i32 s44, s47, 40960
    s_mul_i32 s43, s73, 5120
    s_add_u32 s44, s44, s43
    s_lshl_b32 s43, s48, 8
    s_add_u32 s44, s44, s43
    s_add_u32 s44, s44, 10485760
    s_add_u32 s45, s44, 4096
    s_barrier
    ds_read_b128 v[40:43], v10 offset:0
    ds_read_b128 v[44:47], v10 offset:1024
    ds_read_b128 v[48:51], v10 offset:2048
    ds_read_b128 v[52:55], v10 offset:3072
    ds_read_b128 v[56:59], v10 offset:4096
    ds_read_b32 v60, v4 offset:5120
    s_waitcnt lgkmcnt(1)
    v_pk_add_f32 v[148:149], v[148:149], v[40:41]
    v_pk_add_f32 v[150:151], v[150:151], v[42:43]
    v_pk_add_f32 v[152:153], v[152:153], v[44:45]
    v_pk_add_f32 v[154:155], v[154:155], v[46:47]
    v_pk_add_f32 v[156:157], v[156:157], v[48:49]
    v_pk_add_f32 v[158:159], v[158:159], v[50:51]
    v_pk_add_f32 v[160:161], v[160:161], v[52:53]
    v_pk_add_f32 v[162:163], v[162:163], v[54:55]
    v_pk_add_f32 v[164:165], v[164:165], v[56:57]
    v_pk_add_f32 v[166:167], v[166:167], v[58:59]
    s_waitcnt lgkmcnt(0)
    v_add_f32 v14, v13, v60
    v_pk_add_f32 v[16:17], v[148:149], v[14:15] op_sel_hi:[1,0] neg_lo:[0,1] neg_hi:[0,1]
    v_pk_add_f32 v[18:19], v[150:151], v[14:15] op_sel_hi:[1,0] neg_lo:[0,1] neg_hi:[0,1]
    v_pk_add_f32 v[20:21], v[152:153], v[14:15] op_sel_hi:[1,0] neg_lo:[0,1] neg_hi:[0,1]
    v_pk_add_f32 v[22:23], v[154:155], v[14:15] op_sel_hi:[1,0] neg_lo:[0,1] neg_hi:[0,1]
    v_pk_add_f32 v[24:25], v[156:157], v[14:15] op_sel_hi:[1,0] neg_lo:[0,1] neg_hi:[0,1]
    v_pk_add_f32 v[26:27], v[158:159], v[14:15] op_sel_hi:[1,0] neg_lo:[0,1] neg_hi:[0,1]
    v_pk_add_f32 v[28:29], v[160:161], v[14:15] op_sel_hi:[1,0] neg_lo:[0,1] neg_hi:[0,1]
    v_pk_add_f32 v[30:31], v[162:163], v[14:15] op_sel_hi:[1,0] neg_lo:[0,1] neg_hi:[0,1]
    v_pk_add_f32 v[32:33], v[164:165], v[14:15] op_sel_hi:[1,0] neg_lo:[0,1] neg_hi:[0,1]
    v_pk_add_f32 v[34:35], v[166:167], v[14:15] op_sel_hi:[1,0] neg_lo:[0,1] neg_hi:[0,1]
    v_cvt_pk_bf16_f32 v64, v16, v17
    v_cvt_pk_bf16_f32 v65, v18, v19
    v_cvt_pk_bf16_f32 v66, v20, v21
    v_cvt_pk_bf16_f32 v67, v22, v23
    v_cvt_pk_bf16_f32 v68, v24, v25
    v_cvt_pk_bf16_f32 v69, v26, v27
    v_cvt_pk_bf16_f32 v70, v28, v29
    v_cvt_pk_bf16_f32 v71, v30, v31
    v_cvt_pk_bf16_f32 v72, v32, v33
    v_cvt_pk_bf16_f32 v73, v34, v35
    v_mov_b32 v74, v72
    v_mov_b32 v75, v73
    v_pk_mul_f32 v[10:11], v[16:17], v[16:17]
    v_permlane16_swap_b32 v64, v66
    v_permlane16_swap_b32 v65, v67
    v_permlane16_swap_b32 v68, v70
    v_permlane16_swap_b32 v69, v71
    v_permlane16_swap_b32 v72, v74
    v_permlane16_swap_b32 v73, v75
    buffer_store_dwordx4 v[64:67], v12, s[8:11], s44 offen offset:0 sc1
    buffer_store_dwordx4 v[68:71], v12, s[8:11], s44 offen offset:2048 sc1
    s_mov_b32 exec_lo, 0xffff
    s_mov_b32 exec_hi, 0xffff
    buffer_store_dwordx4 v[72:75], v15, s[8:11], s45 offen sc1
    s_mov_b64 exec, -1
    v_pk_fma_f32 v[10:11], v[18:19], v[18:19], v[10:11]
    v_pk_fma_f32 v[10:11], v[20:21], v[20:21], v[10:11]
    v_pk_fma_f32 v[10:11], v[22:23], v[22:23], v[10:11]
    v_pk_fma_f32 v[10:11], v[24:25], v[24:25], v[10:11]
    v_pk_fma_f32 v[10:11], v[26:27], v[26:27], v[10:11]
    v_pk_fma_f32 v[10:11], v[28:29], v[28:29], v[10:11]
    v_pk_fma_f32 v[10:11], v[30:31], v[30:31], v[10:11]
    v_pk_fma_f32 v[10:11], v[32:33], v[32:33], v[10:11]
    v_pk_fma_f32 v[10:11], v[34:35], v[34:35], v[10:11]
    v_add_f32 v10, v10, v11
    v_mov_b32 v11, v10
    s_nop 1
    v_permlane32_swap_b32 v10, v11
    v_add_f32 v10, v10, v11
    v_mov_b32 v11, v10
    v_lshlrev_b32 v14, 2, v2
    s_nop 0
    v_permlane16_swap_b32 v10, v11
    v_add_f32 v10, v10, v11
    s_mov_b64 exec, 0xffff
    buffer_store_dword v10, v14, s[8:11], s46 offen sc1
    s_mov_b64 exec, -1
    s_waitcnt vmcnt(0)
sequential_preLN__mha_block__glu_gated_geglu__prompt_kernel_p3_done:
    s_barrier
    v_add_u32 v4, 0, v1
    v_lshlrev_b32 v10, 9, v3
    v_lshl_add_u32 v6, v2, 4, v10
    s_lshl_b32 s49, s74, 3
    s_add_u32 s49, s49, s20
    s_mul_i32 s52, s49, 40960
    s_add_u32 s52, s52, 10485760
    s_mov_b32 s44, s52
    s_lshl_b32 s45, s49, 7
    s_add_u32 s45, s45, 13107200
    v_lshlrev_b32 v10, 14, v3
    v_lshl_add_u32 v7, v2, 2, v10
    s_add_u32 s46, s45, 8192
    s_mul_i32 s50, s49, 98304
    s_mul_i32 s43, s75, 3072
    s_add_u32 s50, s50, s43
    s_add_u32 s50, s50, 13172736
    v_mov_b32 v16, 0
    v_mov_b32 v17, 0
    v_mov_b32 v18, 0
    v_mov_b32 v19, 0
    v_mov_b32 v20, 0
    v_mov_b32 v21, 0
    v_mov_b32 v22, 0
    v_mov_b32 v23, 0
    v_mov_b32 v24, 0
    v_mov_b32 v25, 0
    v_mov_b32 v26, 0
    v_mov_b32 v27, 0
    v_mov_b32 v28, 0
    v_mov_b32 v29, 0
    v_mov_b32 v30, 0
    v_mov_b32 v31, 0
    v_mov_b32 v32, 0
    v_mov_b32 v33, 0
    v_mov_b32 v34, 0
    v_mov_b32 v35, 0
    v_mov_b32 v36, 0
    v_mov_b32 v37, 0
    v_mov_b32 v38, 0
    v_mov_b32 v39, 0
    v_mov_b32 v40, 0
    v_mov_b32 v41, 0
    v_mov_b32 v42, 0
    v_mov_b32 v43, 0
    v_mov_b32 v44, 0
    v_mov_b32 v45, 0
    v_mov_b32 v46, 0
    v_mov_b32 v47, 0
    v_mov_b32 v48, 0
    v_mov_b32 v49, 0
    v_mov_b32 v50, 0
    v_mov_b32 v51, 0
    v_mov_b32 v52, 0
    v_mov_b32 v53, 0
    v_mov_b32 v54, 0
    v_mov_b32 v55, 0
    v_mov_b32 v56, 0
    v_mov_b32 v57, 0
    v_mov_b32 v58, 0
    v_mov_b32 v59, 0
    v_mov_b32 v60, 0
    v_mov_b32 v61, 0
    v_mov_b32 v62, 0
    v_mov_b32 v63, 0
    s_mov_b32 s51, 0
    s_setprio 1
    s_cmp_eq_u32 s77, 0
    s_cbranch_scc0 sequential_preLN__mha_block__glu_gated_geglu__prompt_kernel_p4_prio
    s_setprio 2
sequential_preLN__mha_block__glu_gated_geglu__prompt_kernel_p4_prio:
    s_barrier
    ds_read_b128 v[64:67], v4 offset:0
    ds_read_b128 v[68:71], v4 offset:3072
    ds_read_b128 v[72:75], v4 offset:1024
    ds_read_b128 v[76:79], v4 offset:4096
    ds_read_b128 v[80:83], v4 offset:2048
    ds_read_b128 v[84:87], v4 offset:5120
    buffer_load_dwordx4 v[88:91], v6, s[8:11], s44 offen offset:0 sc1
    buffer_load_dwordx4 v[92:95], v6, s[8:11], s44 offen offset:256 sc1
    s_add_u32 s44, s44, 2048
    buffer_load_dwordx4 v[96:99], v6, s[8:11], s44 offen offset:0 sc1
    buffer_load_dwordx4 v[100:103], v6, s[8:11], s44 offen offset:256 sc1
    s_add_u32 s44, s44, 2048
    buffer_load_dwordx4 v[104:107], v6, s[8:11], s44 offen offset:0 sc1
    buffer_load_dwordx4 v[108:111], v6, s[8:11], s44 offen offset:256 sc1
    s_add_u32 s44, s44, 2048
    s_waitcnt vmcnt(4)
    s_waitcnt lgkmcnt(4)
    v_mfma_f32_16x16x32_bf16 v[16:19], v[64:67], v[88:91], v[16:19]
    v_mfma_f32_16x16x32_bf16 v[20:23], v[64:67], v[92:95], v[20:23]
    v_mfma_f32_16x16x32_bf16 v[40:43], v[68:71], v[88:91], v[40:43]
    ds_read_b128 v[64:67], v4 offset:6144
    v_mfma_f32_16x16x32_bf16 v[44:47], v[68:71], v[92:95], v[44:47]
    s_waitcnt lgkmcnt(3)
    v_mfma_f32_16x16x32_bf16 v[24:27], v[72:75], v[88:91], v[24:27]
    ds_read_b128 v[68:71], v4 offset:9216
    v_mfma_f32_16x16x32_bf16 v[28:31], v[72:75], v[92:95], v[28:31]
    v_mfma_f32_16x16x32_bf16 v[48:51], v[76:79], v[88:91], v[48:51]
    ds_read_b128 v[72:75], v4 offset:7168
    v_mfma_f32_16x16x32_bf16 v[52:55], v[76:79], v[92:95], v[52:55]
    s_waitcnt lgkmcnt(3)
    v_mfma_f32_16x16x32_bf16 v[32:35], v[80:83], v[88:91], v[32:35]
    ds_read_b128 v[76:79], v4 offset:10240
    v_mfma_f32_16x16x32_bf16 v[36:39], v[80:83], v[92:95], v[36:39]
    v_mfma_f32_16x16x32_bf16 v[56:59], v[84:87], v[88:91], v[56:59]
    ds_read_b128 v[80:83], v4 offset:8192
    v_mfma_f32_16x16x32_bf16 v[60:63], v[84:87], v[92:95], v[60:63]
    buffer_load_dwordx4 v[112:115], v6, s[8:11], s44 offen offset:0 sc1
    buffer_load_dwordx4 v[116:119], v6, s[8:11], s44 offen offset:256 sc1
    s_add_u32 s44, s44, 2048
    buffer_load_dword v128, v7, s[8:11], s45 offen offset:0 sc1
    buffer_load_dword v129, v7, s[8:11], s46 offen offset:0 sc1
    buffer_load_dword v130, v7, s[8:11], s45 offen offset:64 sc1
    buffer_load_dword v131, v7, s[8:11], s46 offen offset:64 sc1
    buffer_load_dwordx4 v[88:91], v6, s[8:11], s44 offen offset:0 sc1
    buffer_load_dwordx4 v[92:95], v6, s[8:11], s44 offen offset:256 sc1
    s_add_u32 s44, s44, 2048
    s_waitcnt vmcnt(10)
    s_waitcnt lgkmcnt(3)
    v_mfma_f32_16x16x32_bf16 v[16:19], v[64:67], v[96:99], v[16:19]
    ds_read_b128 v[84:87], v4 offset:11264
    v_mfma_f32_16x16x32_bf16 v[20:23], v[64:67], v[100:103], v[20:23]
    v_mfma_f32_16x16x32_bf16 v[40:43], v[68:71], v[96:99], v[40:43]
    ds_read_b128 v[64:67], v4 offset:12288
    v_mfma_f32_16x16x32_bf16 v[44:47], v[68:71], v[100:103], v[44:47]
    s_waitcnt lgkmcnt(3)
    v_mfma_f32_16x16x32_bf16 v[24:27], v[72:75], v[96:99], v[24:27]
    ds_read_b128 v[68:71], v4 offset:15360
    v_mfma_f32_16x16x32_bf16 v[28:31], v[72:75], v[100:103], v[28:31]
    v_mfma_f32_16x16x32_bf16 v[48:51], v[76:79], v[96:99], v[48:51]
    ds_read_b128 v[72:75], v4 offset:13312
    v_mfma_f32_16x16x32_bf16 v[52:55], v[76:79], v[100:103], v[52:55]
    s_waitcnt lgkmcnt(3)
    v_mfma_f32_16x16x32_bf16 v[32:35], v[80:83], v[96:99], v[32:35]
    ds_read_b128 v[76:79], v4 offset:16384
    v_mfma_f32_16x16x32_bf16 v[36:39], v[80:83], v[100:103], v[36:39]
    v_mfma_f32_16x16x32_bf16 v[56:59], v[84:87], v[96:99], v[56:59]
    ds_read_b128 v[80:83], v4 offset:14336
    v_mfma_f32_16x16x32_bf16 v[60:63], v[84:87], v[100:103], v[60:63]
    buffer_load_dwordx4 v[96:99], v6, s[8:11], s44 offen offset:0 sc1
    buffer_load_dwordx4 v[100:103], v6, s[8:11], s44 offen offset:256 sc1
    s_add_u32 s44, s44, 2048
    s_waitcnt vmcnt(10)
    s_waitcnt lgkmcnt(3)
    v_mfma_f32_16x16x32_bf16 v[16:19], v[64:67], v[104:107], v[16:19]
    ds_read_b128 v[84:87], v4 offset:17408
    v_mfma_f32_16x16x32_bf16 v[20:23], v[64:67], v[108:111], v[20:23]
    v_mfma_f32_16x16x32_bf16 v[40:43], v[68:71], v[104:107], v[40:43]
    ds_read_b128 v[64:67], v4 offset:18432
    v_mfma_f32_16x16x32_bf16 v[44:47], v[68:71], v[108:111], v[44:47]
    s_waitcnt lgkmcnt(3)
    v_mfma_f32_16x16x32_bf16 v[24:27], v[72:75], v[104:107], v[24:27]
    ds_read_b128 v[68:71], v4 offset:21504
    v_mfma_f32_16x16x32_bf16 v[28:31], v[72:75], v[108:111], v[28:31]
    v_mfma_f32_16x16x32_bf16 v[48:51], v[76:79], v[104:107], v[48:51]
    ds_read_b128 v[72:75], v4 offset:19456
    v_mfma_f32_16x16x32_bf16 v[52:55], v[76:79], v[108:111], v[52:55]
    s_waitcnt lgkmcnt(3)
    v_mfma_f32_16x16x32_bf16 v[32:35], v[80:83], v[104:107], v[32:35]
    ds_read_b128 v[76:79], v4 offset:22528
    v_mfma_f32_16x16x32_bf16 v[36:39], v[80:83], v[108:111], v[36:39]
    v_mfma_f32_16x16x32_bf16 v[56:59], v[84:87], v[104:107], v[56:59]
    ds_read_b128 v[80:83], v4 offset:20480
    v_mfma_f32_16x16x32_bf16 v[60:63], v[84:87], v[108:111], v[60:63]
    buffer_load_dwordx4 v[104:107], v6, s[8:11], s44 offen offset:0 sc1
    buffer_load_dwordx4 v[108:111], v6, s[8:11], s44 offen offset:256 sc1
    s_add_u32 s44, s44, 2048
    s_waitcnt vmcnt(10)
    s_waitcnt lgkmcnt(3)
    v_mfma_f32_16x16x32_bf16 v[16:19], v[64:67], v[112:115], v[16:19]
    ds_read_b128 v[84:87], v4 offset:23552
    v_mfma_f32_16x16x32_bf16 v[20:23], v[64:67], v[116:119], v[20:23]
    v_mfma_f32_16x16x32_bf16 v[40:43], v[68:71], v[112:115], v[40:43]
    ds_read_b128 v[64:67], v4 offset:24576
    v_mfma_f32_16x16x32_bf16 v[44:47], v[68:71], v[116:119], v[44:47]
    s_waitcnt lgkmcnt(3)
    v_mfma_f32_16x16x32_bf16 v[24:27], v[72:75], v[112:115], v[24:27]
    ds_read_b128 v[68:71], v4 offset:27648
    v_mfma_f32_16x16x32_bf16 v[28:31], v[72:75], v[116:119], v[28:31]
    v_mfma_f32_16x16x32_bf16 v[48:51], v[76:79], v[112:115], v[48:51]
    ds_read_b128 v[72:75], v4 offset:25600
    v_mfma_f32_16x16x32_bf16 v[52:55], v[76:79], v[116:119], v[52:55]
    s_waitcnt lgkmcnt(3)
    v_mfma_f32_16x16x32_bf16 v[32:35], v[80:83], v[112:115], v[32:35]
    ds_read_b128 v[76:79], v4 offset:28672
    v_mfma_f32_16x16x32_bf16 v[36:39], v[80:83], v[116:119], v[36:39]
    v_mfma_f32_16x16x32_bf16 v[56:59], v[84:87], v[112:115], v[56:59]
    ds_read_b128 v[80:83], v4 offset:26624
    v_mfma_f32_16x16x32_bf16 v[60:63], v[84:87], v[116:119], v[60:63]
    ds_read_b128 v[84:87], v4 offset:29696
    buffer_load_dwordx4 v[112:115], v6, s[8:11], s44 offen offset:0 sc1
    buffer_load_dwordx4 v[116:119], v6, s[8:11], s44 offen offset:256 sc1
    s_add_u32 s44, s44, 2048
    v_add_u32 v4, 24576, v4
    s_mov_b32 s51, 1
.p2align 3
sequential_preLN__mha_block__glu_gated_geglu__prompt_kernel_p4_loop:
    s_cmp_eq_u32 s51, 4
    s_cselect_b32 s44, 1073741824, s44
    s_waitcnt vmcnt(6)
    s_waitcnt lgkmcnt(4)
    v_mfma_f32_16x16x32_bf16 v[16:19], v[64:67], v[88:91], v[16:19]
    v_mfma_f32_16x16x32_bf16 v[20:23], v[64:67], v[92:95], v[20:23]
    v_mfma_f32_16x16x32_bf16 v[40:43], v[68:71], v[88:91], v[40:43]
    ds_read_b128 v[64:67], v4 offset:6144
    v_mfma_f32_16x16x32_bf16 v[44:47], v[68:71], v[92:95], v[44:47]
    s_waitcnt lgkmcnt(3)
    v_mfma_f32_16x16x32_bf16 v[24:27], v[72:75], v[88:91], v[24:27]
    ds_read_b128 v[68:71], v4 offset:9216
    v_mfma_f32_16x16x32_bf16 v[28:31], v[72:75], v[92:95], v[28:31]
    v_mfma_f32_16x16x32_bf16 v[48:51], v[76:79], v[88:91], v[48:51]
    ds_read_b128 v[72:75], v4 offset:7168
    v_mfma_f32_16x16x32_bf16 v[52:55], v[76:79], v[92:95], v[52:55]
    s_waitcnt lgkmcnt(3)
    v_mfma_f32_16x16x32_bf16 v[32:35], v[80:83], v[88:91], v[32:35]
    ds_read_b128 v[76:79], v4 offset:10240
    v_mfma_f32_16x16x32_bf16 v[36:39], v[80:83], v[92:95], v[36:39]
    v_mfma_f32_16x16x32_bf16 v[56:59], v[84:87], v[88:91], v[56:59]
    ds_read_b128 v[80:83], v4 offset:8192
    v_mfma_f32_16x16x32_bf16 v[60:63], v[84:87], v[92:95], v[60:63]
    buffer_load_dwordx4 v[88:91], v6, s[8:11], s44 offen offset:0 sc1
    buffer_load_dwordx4 v[92:95], v6, s[8:11], s44 offen offset:256 sc1
    s_add_u32 s44, s44, 2048
    s_waitcnt vmcnt(6)
    s_waitcnt lgkmcnt(3)
    v_mfma_f32_16x16x32_bf16 v[16:19], v[64:67], v[96:99], v[16:19]
    ds_read_b128 v[84:87], v4 offset:11264
    v_mfma_f32_16x16x32_bf16 v[20:23], v[64:67], v[100:103], v[20:23]
    v_mfma_f32_16x16x32_bf16 v[40:43], v[68:71], v[96:99], v[40:43]
    ds_read_b128 v[64:67], v4 offset:12288
    v_mfma_f32_16x16x32_bf16 v[44:47], v[68:71], v[100:103], v[44:47]
    s_waitcnt lgkmcnt(3)
    v_mfma_f32_16x16x32_bf16 v[24:27], v[72:75], v[96:99], v[24:27]
    ds_read_b128 v[68:71], v4 offset:15360
    v_mfma_f32_16x16x32_bf16 v[28:31], v[72:75], v[100:103], v[28:31]
    v_mfma_f32_16x16x32_bf16 v[48:51], v[76:79], v[96:99], v[48:51]
    ds_read_b128 v[72:75], v4 offset:13312
    v_mfma_f32_16x16x32_bf16 v[52:55], v[76:79], v[100:103], v[52:55]
    s_waitcnt lgkmcnt(3)
    v_mfma_f32_16x16x32_bf16 v[32:35], v[80:83], v[96:99], v[32:35]
    ds_read_b128 v[76:79], v4 offset:16384
    v_mfma_f32_16x16x32_bf16 v[36:39], v[80:83], v[100:103], v[36:39]
    v_mfma_f32_16x16x32_bf16 v[56:59], v[84:87], v[96:99], v[56:59]
    ds_read_b128 v[80:83], v4 offset:14336
    v_mfma_f32_16x16x32_bf16 v[60:63], v[84:87], v[100:103], v[60:63]
    buffer_load_dwordx4 v[96:99], v6, s[8:11], s44 offen offset:0 sc1
    buffer_load_dwordx4 v[100:103], v6, s[8:11], s44 offen offset:256 sc1
    s_add_u32 s44, s44, 2048
    s_waitcnt vmcnt(6)
    s_waitcnt lgkmcnt(3)
    v_mfma_f32_16x16x32_bf16 v[16:19], v[64:67], v[104:107], v[16:19]
    ds_read_b128 v[84:87], v4 offset:17408
    v_mfma_f32_16x16x32_bf16 v[20:23], v[64:67], v[108:111], v[20:23]
    v_mfma_f32_16x16x32_bf16 v[40:43], v[68:71], v[104:107], v[40:43]
    ds_read_b128 v[64:67], v4 offset:18432
    v_mfma_f32_16x16x32_bf16 v[44:47], v[68:71], v[108:111], v[44:47]
    s_waitcnt lgkmcnt(3)
    v_mfma_f32_16x16x32_bf16 v[24:27], v[72:75], v[104:107], v[24:27]
    ds_read_b128 v[68:71], v4 offset:21504
    v_mfma_f32_16x16x32_bf16 v[28:31], v[72:75], v[108:111], v[28:31]
    v_mfma_f32_16x16x32_bf16 v[48:51], v[76:79], v[104:107], v[48:51]
    ds_read_b128 v[72:75], v4 offset:19456
    v_mfma_f32_16x16x32_bf16 v[52:55], v[76:79], v[108:111], v[52:55]
    s_waitcnt lgkmcnt(3)
    v_mfma_f32_16x16x32_bf16 v[32:35], v[80:83], v[104:107], v[32:35]
    ds_read_b128 v[76:79], v4 offset:22528
    v_mfma_f32_16x16x32_bf16 v[36:39], v[80:83], v[108:111], v[36:39]
    v_mfma_f32_16x16x32_bf16 v[56:59], v[84:87], v[104:107], v[56:59]
    ds_read_b128 v[80:83], v4 offset:20480
    v_mfma_f32_16x16x32_bf16 v[60:63], v[84:87], v[108:111], v[60:63]
    buffer_load_dwordx4 v[104:107], v6, s[8:11], s44 offen offset:0 sc1
    buffer_load_dwordx4 v[108:111], v6, s[8:11], s44 offen offset:256 sc1
    s_add_u32 s44, s44, 2048
    s_waitcnt vmcnt(6)
    s_waitcnt lgkmcnt(3)
    v_mfma_f32_16x16x32_bf16 v[16:19], v[64:67], v[112:115], v[16:19]
    ds_read_b128 v[84:87], v4 offset:23552
    v_mfma_f32_16x16x32_bf16 v[20:23], v[64:67], v[116:119], v[20:23]
    v_mfma_f32_16x16x32_bf16 v[40:43], v[68:71], v[112:115], v[40:43]
    ds_read_b128 v[64:67], v4 offset:24576
    v_mfma_f32_16x16x32_bf16 v[44:47], v[68:71], v[116:119], v[44:47]
    s_waitcnt lgkmcnt(3)
    v_mfma_f32_16x16x32_bf16 v[24:27], v[72:75], v[112:115], v[24:27]
    ds_read_b128 v[68:71], v4 offset:27648
    v_mfma_f32_16x16x32_bf16 v[28:31], v[72:75], v[116:119], v[28:31]
    v_mfma_f32_16x16x32_bf16 v[48:51], v[76:79], v[112:115], v[48:51]
    ds_read_b128 v[72:75], v4 offset:25600
    v_mfma_f32_16x16x32_bf16 v[52:55], v[76:79], v[116:119], v[52:55]
    s_waitcnt lgkmcnt(3)
    v_mfma_f32_16x16x32_bf16 v[32:35], v[80:83], v[112:115], v[32:35]
    ds_read_b128 v[76:79], v4 offset:28672
    v_mfma_f32_16x16x32_bf16 v[36:39], v[80:83], v[116:119], v[36:39]
    v_mfma_f32_16x16x32_bf16 v[56:59], v[84:87], v[112:115], v[56:59]
    ds_read_b128 v[80:83], v4 offset:26624
    v_mfma_f32_16x16x32_bf16 v[60:63], v[84:87], v[116:119], v[60:63]
    ds_read_b128 v[84:87], v4 offset:29696
    buffer_load_dwordx4 v[112:115], v6, s[8:11], s44 offen offset:0 sc1
    buffer_load_dwordx4 v[116:119], v6, s[8:11], s44 offen offset:256 sc1
    s_add_u32 s44, s44, 2048
    s_cmp_eq_u32 s51, 1
    s_cbranch_scc1 sequential_preLN__mha_block__glu_gated_geglu__prompt_kernel_p4_stats
sequential_preLN__mha_block__glu_gated_geglu__prompt_kernel_p4_statsback:
    v_add_u32 v4, 24576, v4
    s_add_u32 s51, s51, 1
    s_cmp_lt_u32 s51, 5
    s_cbranch_scc1 sequential_preLN__mha_block__glu_gated_geglu__prompt_kernel_p4_loop
    s_waitcnt lgkmcnt(0)
    s_cmp_eq_u32 s77, 0
    s_cbranch_scc1 sequential_preLN__mha_block__glu_gated_geglu__prompt_kernel_p4_lead
    s_barrier
sequential_preLN__mha_block__glu_gated_geglu__prompt_kernel_p4_lead:
    s_setprio 0
    s_cmp_eq_u32 s77, 0
    s_cbranch_scc1 sequential_preLN__mha_block__glu_gated_geglu__prompt_kernel_p4_scalar
    v_pk_mul_f32 v[64:65], v[16:17], v[16:17]
    v_pk_mul_f32 v[66:67], v[18:19], v[18:19]
    v_pk_mul_f32 v[68:69], v[20:21], v[20:21]
    v_pk_mul_f32 v[70:71], v[22:23], v[22:23]
    v_pk_fma_f32 v[64:65], v[64:65], v[136:137], v[134:135] op_sel:[0,0,0] op_sel_hi:[1,0,0]
    v_pk_fma_f32 v[66:67], v[66:67], v[136:137], v[134:135] op_sel:[0,0,0] op_sel_hi:[1,0,0]
    v_pk_fma_f32 v[68:69], v[68:69], v[136:137], v[134:135] op_sel:[0,1,1] op_sel_hi:[1,1,1]
    v_pk_fma_f32 v[70:71], v[70:71], v[136:137], v[134:135] op_sel:[0,1,1] op_sel_hi:[1,1,1]
    v_pk_mul_f32 v[64:65], v[64:65], v[16:17]
    v_pk_mul_f32 v[66:67], v[66:67], v[18:19]
    v_pk_mul_f32 v[68:69], v[68:69], v[20:21]
    v_pk_mul_f32 v[70:71], v[70:71], v[22:23]
    v_exp_f32 v64, v64
    v_exp_f32 v65, v65
    v_exp_f32 v66, v66
    v_exp_f32 v67, v67
    v_exp_f32 v68, v68
    v_exp_f32 v69, v69
    v_exp_f32 v70, v70
    v_exp_f32 v71, v71
    v_pk_mul_f32 v[16:17], v[16:17], v[40:41]
    v_pk_mul_f32 v[18:19], v[18:19], v[42:43]
    v_pk_mul_f32 v[20:21], v[20:21], v[44:45]
    v_pk_mul_f32 v[22:23], v[22:23], v[46:47]
    v_pk_fma_f32 v[64:65], v[64:65], v[132:133], v[132:133] op_sel:[0,0,0] op_sel_hi:[1,0,0]
    v_pk_fma_f32 v[66:67], v[66:67], v[132:133], v[132:133] op_sel:[0,0,0] op_sel_hi:[1,0,0]
    v_pk_fma_f32 v[68:69], v[68:69], v[132:133], v[132:133] op_sel:[0,1,1] op_sel_hi:[1,1,1]
    v_pk_fma_f32 v[70:71], v[70:71], v[132:133], v[132:133] op_sel:[0,1,1] op_sel_hi:[1,1,1]
    v_rcp_f32 v64, v64
    v_rcp_f32 v65, v65
    v_rcp_f32 v66, v66
    v_rcp_f32 v67, v67
    v_rcp_f32 v68, v68
    v_rcp_f32 v69, v69
    v_rcp_f32 v70, v70
    v_rcp_f32 v71, v71
    s_nop 0
    v_pk_mul_f32 v[16:17], v[16:17], v[64:65]
    v_pk_mul_f32 v[18:19], v[18:19], v[66:67]
    v_pk_mul_f32 v[20:21], v[20:21], v[68:69]
    v_pk_mul_f32 v[22:23], v[22:23], v[70:71]
    v_cvt_pk_bf16_f32 v72, v16, v17
    v_cvt_pk_bf16_f32 v73, v18, v19
    v_cvt_pk_bf16_f32 v74, v20, v21
    v_cvt_pk_bf16_f32 v75, v22, v23
    s_nop 1
    v_permlane16_swap_b32 v72, v74
    v_permlane16_swap_b32 v73, v75
    buffer_store_dwordx4 v[72:75], v1, s[8:11], s50 offen offset:0 sc1
    v_pk_mul_f32 v[64:65], v[24:25], v[24:25]
    v_pk_mul_f32 v[66:67], v[26:27], v[26:27]
    v_pk_mul_f32 v[68:69], v[28:29], v[28:29]
    v_pk_mul_f32 v[70:71], v[30:31], v[30:31]
    v_pk_fma_f32 v[64:65], v[64:65], v[136:137], v[134:135] op_sel:[0,0,0] op_sel_hi:[1,0,0]
    v_pk_fma_f32 v[66:67], v[66:67], v[136:137], v[134:135] op_sel:[0,0,0] op_sel_hi:[1,0,0]
    v_pk_fma_f32 v[68:69], v[68:69], v[136:137], v[134:135] op_sel:[0,1,1] op_sel_hi:[1,1,1]
    v_pk_fma_f32 v[70:71], v[70:71], v[136:137], v[134:135] op_sel:[0,1,1] op_sel_hi:[1,1,1]
    v_pk_mul_f32 v[64:65], v[64:65], v[24:25]
    v_pk_mul_f32 v[66:67], v[66:67], v[26:27]
    v_pk_mul_f32 v[68:69], v[68:69], v[28:29]
    v_pk_mul_f32 v[70:71], v[70:71], v[30:31]
    v_exp_f32 v64, v64
    v_exp_f32 v65, v65
    v_exp_f32 v66, v66
    v_exp_f32 v67, v67
    v_exp_f32 v68, v68
    v_exp_f32 v69, v69
    v_exp_f32 v70, v70
    v_exp_f32 v71, v71
    v_pk_mul_f32 v[24:25], v[24:25], v[48:49]
    v_pk_mul_f32 v[26:27], v[26:27], v[50:51]
    v_pk_mul_f32 v[28:29], v[28:29], v[52:53]
    v_pk_mul_f32 v[30:31], v[30:31], v[54:55]
    v_pk_fma_f32 v[64:65], v[64:65], v[132:133], v[132:133] op_sel:[0,0,0] op_sel_hi:[1,0,0]
    v_pk_fma_f32 v[66:67], v[66:67], v[132:133], v[132:133] op_sel:[0,0,0] op_sel_hi:[1,0,0]
    v_pk_fma_f32 v[68:69], v[68:69], v[132:133], v[132:133] op_sel:[0,1,1] op_sel_hi:[1,1,1]
    v_pk_fma_f32 v[70:71], v[70:71], v[132:133], v[132:133] op_sel:[0,1,1] op_sel_hi:[1,1,1]
    v_rcp_f32 v64, v64
    v_rcp_f32 v65, v65
    v_rcp_f32 v66, v66
    v_rcp_f32 v67, v67
    v_rcp_f32 v68, v68
    v_rcp_f32 v69, v69
    v_rcp_f32 v70, v70
    v_rcp_f32 v71, v71
    s_nop 0
    v_pk_mul_f32 v[24:25], v[24:25], v[64:65]
    v_pk_mul_f32 v[26:27], v[26:27], v[66:67]
    v_pk_mul_f32 v[28:29], v[28:29], v[68:69]
    v_pk_mul_f32 v[30:31], v[30:31], v[70:71]
    v_cvt_pk_bf16_f32 v76, v24, v25
    v_cvt_pk_bf16_f32 v77, v26, v27
    v_cvt_pk_bf16_f32 v78, v28, v29
    v_cvt_pk_bf16_f32 v79, v30, v31
    s_nop 1
    v_permlane16_swap_b32 v76, v78
    v_permlane16_swap_b32 v77, v79
    buffer_store_dwordx4 v[76:79], v1, s[8:11], s50 offen offset:1024 sc1
    v_pk_mul_f32 v[64:65], v[32:33], v[32:33]
    v_pk_mul_f32 v[66:67], v[34:35], v[34:35]
    v_pk_mul_f32 v[68:69], v[36:37], v[36:37]
    v_pk_mul_f32 v[70:71], v[38:39], v[38:39]
    v_pk_fma_f32 v[64:65], v[64:65], v[136:137], v[134:135] op_sel:[0,0,0] op_sel_hi:[1,0,0]
    v_pk_fma_f32 v[66:67], v[66:67], v[136:137], v[134:135] op_sel:[0,0,0] op_sel_hi:[1,0,0]
    v_pk_fma_f32 v[68:69], v[68:69], v[136:137], v[134:135] op_sel:[0,1,1] op_sel_hi:[1,1,1]
    v_pk_fma_f32 v[70:71], v[70:71], v[136:137], v[134:135] op_sel:[0,1,1] op_sel_hi:[1,1,1]
    v_pk_mul_f32 v[64:65], v[64:65], v[32:33]
    v_pk_mul_f32 v[66:67], v[66:67], v[34:35]
    v_pk_mul_f32 v[68:69], v[68:69], v[36:37]
    v_pk_mul_f32 v[70:71], v[70:71], v[38:39]
    v_exp_f32 v64, v64
    v_exp_f32 v65, v65
    v_exp_f32 v66, v66
    v_exp_f32 v67, v67
    v_exp_f32 v68, v68
    v_exp_f32 v69, v69
    v_exp_f32 v70, v70
    v_exp_f32 v71, v71
    v_pk_mul_f32 v[32:33], v[32:33], v[56:57]
    v_pk_mul_f32 v[34:35], v[34:35], v[58:59]
    v_pk_mul_f32 v[36:37], v[36:37], v[60:61]
    v_pk_mul_f32 v[38:39], v[38:39], v[62:63]
    v_pk_fma_f32 v[64:65], v[64:65], v[132:133], v[132:133] op_sel:[0,0,0] op_sel_hi:[1,0,0]
    v_pk_fma_f32 v[66:67], v[66:67], v[132:133], v[132:133] op_sel:[0,0,0] op_sel_hi:[1,0,0]
    v_pk_fma_f32 v[68:69], v[68:69], v[132:133], v[132:133] op_sel:[0,1,1] op_sel_hi:[1,1,1]
    v_pk_fma_f32 v[70:71], v[70:71], v[132:133], v[132:133] op_sel:[0,1,1] op_sel_hi:[1,1,1]
    v_rcp_f32 v64, v64
    v_rcp_f32 v65, v65
    v_rcp_f32 v66, v66
    v_rcp_f32 v67, v67
    v_rcp_f32 v68, v68
    v_rcp_f32 v69, v69
    v_rcp_f32 v70, v70
    v_rcp_f32 v71, v71
    s_nop 0
    v_pk_mul_f32 v[32:33], v[32:33], v[64:65]
    v_pk_mul_f32 v[34:35], v[34:35], v[66:67]
    v_pk_mul_f32 v[36:37], v[36:37], v[68:69]
    v_pk_mul_f32 v[38:39], v[38:39], v[70:71]
    v_cvt_pk_bf16_f32 v80, v32, v33
    v_cvt_pk_bf16_f32 v81, v34, v35
    v_cvt_pk_bf16_f32 v82, v36, v37
    v_cvt_pk_bf16_f32 v83, v38, v39
    s_nop 1
    v_permlane16_swap_b32 v80, v82
    v_permlane16_swap_b32 v81, v83
    buffer_store_dwordx4 v[80:83], v1, s[8:11], s50 offen offset:2048 sc1
sequential_preLN__mha_block__glu_gated_geglu__prompt_kernel_p4_gelu_done:
    s_cmp_eq_u32 s77, 0
    s_cbranch_scc0 sequential_preLN__mha_block__glu_gated_geglu__prompt_kernel_p4_lag
    s_barrier
sequential_preLN__mha_block__glu_gated_geglu__prompt_kernel_p4_lag:
    s_and_b32 s49, s20, 1
    s_mul_i32 s42, s49, 5120
    v_add_u32 v4, s42, v1
    v_add_u32 v5, 40960, v4
    s_mul_i32 s44, s47, 98304
    s_mul_i32 s43, s49, 49152
    s_add_u32 s44, s44, s43
    s_add_u32 s44, s44, 13172736
    s_lshl_b32 s43, s49, 8
    v_add_u32 v7, s43, v6
    v_xor_b32 v8, 256, v7
    v_mov_b32 v16, 0
    v_mov_b32 v17, 0
    v_mov_b32 v18, 0
    v_mov_b32 v19, 0
    v_mov_b32 v20, 0
    v_mov_b32 v21, 0
    v_mov_b32 v22, 0
    v_mov_b32 v23, 0
    v_mov_b32 v24, 0
    v_mov_b32 v25, 0
    v_mov_b32 v26, 0
    v_mov_b32 v27, 0
    v_mov_b32 v28, 0
    v_mov_b32 v29, 0
    v_mov_b32 v30, 0
    v_mov_b32 v31, 0
    v_mov_b32 v32, 0
    v_mov_b32 v33, 0
    v_mov_b32 v34, 0
    v_mov_b32 v35, 0
    v_mov_b32 v36, 0
    v_mov_b32 v37, 0
    v_mov_b32 v38, 0
    v_mov_b32 v39, 0
    v_mov_b32 v40, 0
    v_mov_b32 v41, 0
    v_mov_b32 v42, 0
    v_mov_b32 v43, 0
    v_mov_b32 v44, 0
    v_mov_b32 v45, 0
    v_mov_b32 v46, 0
    v_mov_b32 v47, 0
    v_mov_b32 v48, 0
    v_mov_b32 v49, 0
    v_mov_b32 v50, 0
    v_mov_b32 v51, 0
    v_mov_b32 v52, 0
    v_mov_b32 v53, 0
    v_mov_b32 v54, 0
    v_mov_b32 v55, 0
    s_mov_b32 s51, 0
    s_setprio 0
    s_mov_b32 s53, 40960
    s_mov_b32 s52, 4294844416
    s_waitcnt vmcnt(0)
    s_barrier
    s_cmp_eq_u32 s77, 0
    s_cbranch_scc0 sequential_preLN__mha_block__glu_gated_geglu__prompt_kernel_done
    s_barrier
    buffer_load_dwordx4 v[96:99], v7, s[8:11], s44 offen offset:0 sc1
    buffer_load_dwordx4 v[100:103], v8, s[8:11], s44 offen offset:0 sc1
    buffer_load_dwordx4 v[104:107], v7, s[8:11], s44 offen offset:2048 sc1
    buffer_load_dwordx4 v[108:111], v8, s[8:11], s44 offen offset:2048 sc1
    s_add_u32 s44, s44, 4096
    buffer_load_dwordx4 v[112:115], v7, s[8:11], s44 offen offset:0 sc1
    buffer_load_dwordx4 v[116:119], v8, s[8:11], s44 offen offset:0 sc1
    buffer_load_dwordx4 v[120:123], v7, s[8:11], s44 offen offset:2048 sc1
    buffer_load_dwordx4 v[124:127], v8, s[8:11], s44 offen offset:2048 sc1
    s_add_u32 s44, s44, 4096
    ds_read_b128 v[56:59], v4 offset:0
    ds_read_b128 v[60:63], v4 offset:1024
    ds_read_b128 v[64:67], v4 offset:2048
    ds_read_b128 v[68:71], v4 offset:3072
    ds_read_b128 v[72:75], v4 offset:4096
    ds_read_b128 v[76:79], v4 offset:10240
    ds_read_b128 v[80:83], v4 offset:11264
    ds_read_b128 v[84:87], v4 offset:12288
    ds_read_b128 v[88:91], v4 offset:13312
    ds_read_b128 v[92:95], v4 offset:14336
    s_waitcnt vmcnt(6) lgkmcnt(5)
    v_mfma_f32_16x16x32_bf16 v[16:19], v[56:59], v[96:99], v[16:19]
    v_mfma_f32_16x16x32_bf16 v[36:39], v[56:59], v[100:103], v[36:39]
    ds_read_b128 v[56:59], v4 offset:20480
    v_mfma_f32_16x16x32_bf16 v[20:23], v[60:63], v[96:99], v[20:23]
    v_mfma_f32_16x16x32_bf16 v[40:43], v[60:63], v[100:103], v[40:43]
    ds_read_b128 v[60:63], v4 offset:21504
    v_mfma_f32_16x16x32_bf16 v[24:27], v[64:67], v[96:99], v[24:27]
    v_mfma_f32_16x16x32_bf16 v[44:47], v[64:67], v[100:103], v[44:47]
    ds_read_b128 v[64:67], v4 offset:22528
    buffer_load_dwordx4 v[128:131], v7, s[8:11], s44 offen offset:0 sc1
    buffer_load_dwordx4 v[132:135], v8, s[8:11], s44 offen offset:0 sc1
    v_mfma_f32_16x16x32_bf16 v[28:31], v[68:71], v[96:99], v[28:31]
    v_mfma_f32_16x16x32_bf16 v[48:51], v[68:71], v[100:103], v[48:51]
    ds_read_b128 v[68:71], v4 offset:23552
    v_mfma_f32_16x16x32_bf16 v[32:35], v[72:75], v[96:99], v[32:35]
    v_mfma_f32_16x16x32_bf16 v[52:55], v[72:75], v[100:103], v[52:55]
    ds_read_b128 v[72:75], v4 offset:24576
    buffer_load_dwordx4 v[136:139], v7, s[8:11], s44 offen offset:2048 sc1
    buffer_load_dwordx4 v[140:143], v8, s[8:11], s44 offen offset:2048 sc1
    s_add_u32 s44, s44, 4096
    s_waitcnt vmcnt(8) lgkmcnt(5)
    v_mfma_f32_16x16x32_bf16 v[16:19], v[76:79], v[104:107], v[16:19]
    v_mfma_f32_16x16x32_bf16 v[36:39], v[76:79], v[108:111], v[36:39]
    ds_read_b128 v[76:79], v4 offset:30720
    v_mfma_f32_16x16x32_bf16 v[20:23], v[80:83], v[104:107], v[20:23]
    v_mfma_f32_16x16x32_bf16 v[40:43], v[80:83], v[108:111], v[40:43]
    ds_read_b128 v[80:83], v4 offset:31744
    v_mfma_f32_16x16x32_bf16 v[24:27], v[84:87], v[104:107], v[24:27]
    v_mfma_f32_16x16x32_bf16 v[44:47], v[84:87], v[108:111], v[44:47]
    ds_read_b128 v[84:87], v4 offset:32768
    buffer_load_dwordx4 v[96:99], v7, s[8:11], s44 offen offset:0 sc1
    buffer_load_dwordx4 v[100:103], v8, s[8:11], s44 offen offset:0 sc1
    v_mfma_f32_16x16x32_bf16 v[28:31], v[88:91], v[104:107], v[28:31]
    v_mfma_f32_16x16x32_bf16 v[48:51], v[88:91], v[108:111], v[48:51]
    ds_read_b128 v[88:91], v4 offset:33792
    v_mfma_f32_16x16x32_bf16 v[32:35], v[92:95], v[104:107], v[32:35]
    v_mfma_f32_16x16x32_bf16 v[52:55], v[92:95], v[108:111], v[52:55]
    ds_read_b128 v[92:95], v4 offset:34816
    v_add_u32 v4, 81920, v4
    v_subrev_u32 v14, 163840, v4
    v_min_u32 v4, v4, v14
    buffer_load_dwordx4 v[104:107], v7, s[8:11], s44 offen offset:2048 sc1
    buffer_load_dwordx4 v[108:111], v8, s[8:11], s44 offen offset:2048 sc1
    s_add_u32 s44, s44, 4096
    s_waitcnt vmcnt(10) lgkmcnt(5)
    v_mfma_f32_16x16x32_bf16 v[16:19], v[56:59], v[112:115], v[16:19]
    v_mfma_f32_16x16x32_bf16 v[36:39], v[56:59], v[116:119], v[36:39]
    ds_read_b128 v[56:59], v5 offset:0
    v_mfma_f32_16x16x32_bf16 v[20:23], v[60:63], v[112:115], v[20:23]
    v_mfma_f32_16x16x32_bf16 v[40:43], v[60:63], v[116:119], v[40:43]
    ds_read_b128 v[60:63], v5 offset:1024
    v_mfma_f32_16x16x32_bf16 v[24:27], v[64:67], v[112:115], v[24:27]
    v_mfma_f32_16x16x32_bf16 v[44:47], v[64:67], v[116:119], v[44:47]
    ds_read_b128 v[64:67], v5 offset:2048
    v_mfma_f32_16x16x32_bf16 v[28:31], v[68:71], v[112:115], v[28:31]
    v_mfma_f32_16x16x32_bf16 v[48:51], v[68:71], v[116:119], v[48:51]
    ds_read_b128 v[68:71], v5 offset:3072
    v_mfma_f32_16x16x32_bf16 v[32:35], v[72:75], v[112:115], v[32:35]
    v_mfma_f32_16x16x32_bf16 v[52:55], v[72:75], v[116:119], v[52:55]
    ds_read_b128 v[72:75], v5 offset:4096
    buffer_load_dwordx4 v[112:115], v7, s[8:11], s44 offen offset:0 sc1
    buffer_load_dwordx4 v[116:119], v8, s[8:11], s44 offen offset:0 sc1
    s_waitcnt vmcnt(10) lgkmcnt(5)
    v_mfma_f32_16x16x32_bf16 v[16:19], v[76:79], v[120:123], v[16:19]
    v_mfma_f32_16x16x32_bf16 v[36:39], v[76:79], v[124:127], v[36:39]
    ds_read_b128 v[76:79], v5 offset:10240
    v_mfma_f32_16x16x32_bf16 v[20:23], v[80:83], v[120:123], v[20:23]
    v_mfma_f32_16x16x32_bf16 v[40:43], v[80:83], v[124:127], v[40:43]
    ds_read_b128 v[80:83], v5 offset:11264
    v_mfma_f32_16x16x32_bf16 v[24:27], v[84:87], v[120:123], v[24:27]
    v_mfma_f32_16x16x32_bf16 v[44:47], v[84:87], v[124:127], v[44:47]
    ds_read_b128 v[84:87], v5 offset:12288
    v_mfma_f32_16x16x32_bf16 v[28:31], v[88:91], v[120:123], v[28:31]
    v_mfma_f32_16x16x32_bf16 v[48:51], v[88:91], v[124:127], v[48:51]
    ds_read_b128 v[88:91], v5 offset:13312
    v_mfma_f32_16x16x32_bf16 v[32:35], v[92:95], v[120:123], v[32:35]
    v_mfma_f32_16x16x32_bf16 v[52:55], v[92:95], v[124:127], v[52:55]
    ds_read_b128 v[92:95], v5 offset:14336
    buffer_load_dwordx4 v[120:123], v7, s[8:11], s44 offen offset:2048 sc1
    buffer_load_dwordx4 v[124:127], v8, s[8:11], s44 offen offset:2048 sc1
    s_add_u32 s44, s44, 4096
    s_waitcnt vmcnt(10) lgkmcnt(5)
    v_mfma_f32_16x16x32_bf16 v[16:19], v[56:59], v[128:131], v[16:19]
    v_mfma_f32_16x16x32_bf16 v[36:39], v[56:59], v[132:135], v[36:39]
    ds_read_b128 v[56:59], v5 offset:20480
    v_mfma_f32_16x16x32_bf16 v[20:23], v[60:63], v[128:131], v[20:23]
    v_mfma_f32_16x16x32_bf16 v[40:43], v[60:63], v[132:135], v[40:43]
    ds_read_b128 v[60:63], v5 offset:21504
    v_mfma_f32_16x16x32_bf16 v[24:27], v[64:67], v[128:131], v[24:27]
    v_mfma_f32_16x16x32_bf16 v[44:47], v[64:67], v[132:135], v[44:47]
    ds_read_b128 v[64:67], v5 offset:22528
    v_mfma_f32_16x16x32_bf16 v[28:31], v[68:71], v[128:131], v[28:31]
    v_mfma_f32_16x16x32_bf16 v[48:51], v[68:71], v[132:135], v[48:51]
    ds_read_b128 v[68:71], v5 offset:23552
    v_mfma_f32_16x16x32_bf16 v[32:35], v[72:75], v[128:131], v[32:35]
    v_mfma_f32_16x16x32_bf16 v[52:55], v[72:75], v[132:135], v[52:55]
    ds_read_b128 v[72:75], v5 offset:24576
    buffer_load_dwordx4 v[128:131], v7, s[8:11], s44 offen offset:0 sc1
    buffer_load_dwordx4 v[132:135], v8, s[8:11], s44 offen offset:0 sc1
    s_waitcnt vmcnt(10) lgkmcnt(5)
    v_mfma_f32_16x16x32_bf16 v[16:19], v[76:79], v[136:139], v[16:19]
    v_mfma_f32_16x16x32_bf16 v[36:39], v[76:79], v[140:143], v[36:39]
    ds_read_b128 v[76:79], v5 offset:30720
    v_mfma_f32_16x16x32_bf16 v[20:23], v[80:83], v[136:139], v[20:23]
    v_mfma_f32_16x16x32_bf16 v[40:43], v[80:83], v[140:143], v[40:43]
    ds_read_b128 v[80:83], v5 offset:31744
    v_mfma_f32_16x16x32_bf16 v[24:27], v[84:87], v[136:139], v[24:27]
    v_mfma_f32_16x16x32_bf16 v[44:47], v[84:87], v[140:143], v[44:47]
    ds_read_b128 v[84:87], v5 offset:32768
    v_mfma_f32_16x16x32_bf16 v[28:31], v[88:91], v[136:139], v[28:31]
    v_mfma_f32_16x16x32_bf16 v[48:51], v[88:91], v[140:143], v[48:51]
    ds_read_b128 v[88:91], v5 offset:33792
    v_mfma_f32_16x16x32_bf16 v[32:35], v[92:95], v[136:139], v[32:35]
    v_mfma_f32_16x16x32_bf16 v[52:55], v[92:95], v[140:143], v[52:55]
    ds_read_b128 v[92:95], v5 offset:34816
    v_add_u32 v5, 81920, v5
    v_subrev_u32 v14, 163840, v5
    v_min_u32 v5, v5, v14
    buffer_load_dwordx4 v[136:139], v7, s[8:11], s44 offen offset:2048 sc1
    buffer_load_dwordx4 v[140:143], v8, s[8:11], s44 offen offset:2048 sc1
    s_add_u32 s44, s44, 4096
    s_waitcnt vmcnt(10) lgkmcnt(5)
    s_barrier
    v_mfma_f32_16x16x32_bf16 v[16:19], v[56:59], v[96:99], v[16:19]
    v_mfma_f32_16x16x32_bf16 v[36:39], v[56:59], v[100:103], v[36:39]
    ds_read_b128 v[56:59], v4 offset:0
    v_mfma_f32_16x16x32_bf16 v[20:23], v[60:63], v[96:99], v[20:23]
    v_mfma_f32_16x16x32_bf16 v[40:43], v[60:63], v[100:103], v[40:43]
    ds_read_b128 v[60:63], v4 offset:1024
    v_mfma_f32_16x16x32_bf16 v[24:27], v[64:67], v[96:99], v[24:27]
    v_mfma_f32_16x16x32_bf16 v[44:47], v[64:67], v[100:103], v[44:47]
    ds_read_b128 v[64:67], v4 offset:2048
    v_mfma_f32_16x16x32_bf16 v[28:31], v[68:71], v[96:99], v[28:31]
    v_mfma_f32_16x16x32_bf16 v[48:51], v[68:71], v[100:103], v[48:51]
    ds_read_b128 v[68:71], v4 offset:3072
    v_mfma_f32_16x16x32_bf16 v[32:35], v[72:75], v[96:99], v[32:35]
    v_mfma_f32_16x16x32_bf16 v[52:55], v[72:75], v[100:103], v[52:55]
    ds_read_b128 v[72:75], v4 offset:4096
    buffer_load_dwordx4 v[96:99], v7, s[8:11], s44 offen offset:0 sc1
    buffer_load_dwordx4 v[100:103], v8, s[8:11], s44 offen offset:0 sc1
    s_waitcnt vmcnt(10) lgkmcnt(5)
    v_mfma_f32_16x16x32_bf16 v[16:19], v[76:79], v[104:107], v[16:19]
    v_mfma_f32_16x16x32_bf16 v[36:39], v[76:79], v[108:111], v[36:39]
    ds_read_b128 v[76:79], v4 offset:10240
    v_mfma_f32_16x16x32_bf16 v[20:23], v[80:83], v[104:107], v[20:23]
    v_mfma_f32_16x16x32_bf16 v[40:43], v[80:83], v[108:111], v[40:43]
    ds_read_b128 v[80:83], v4 offset:11264
    v_mfma_f32_16x16x32_bf16 v[24:27], v[84:87], v[104:107], v[24:27]
    v_mfma_f32_16x16x32_bf16 v[44:47], v[84:87], v[108:111], v[44:47]
    ds_read_b128 v[84:87], v4 offset:12288
    v_mfma_f32_16x16x32_bf16 v[28:31], v[88:91], v[104:107], v[28:31]
    v_mfma_f32_16x16x32_bf16 v[48:51], v[88:91], v[108:111], v[48:51]
    ds_read_b128 v[88:91], v4 offset:13312
    v_mfma_f32_16x16x32_bf16 v[32:35], v[92:95], v[104:107], v[32:35]
    v_mfma_f32_16x16x32_bf16 v[52:55], v[92:95], v[108:111], v[52:55]
    ds_read_b128 v[92:95], v4 offset:14336
    buffer_load_dwordx4 v[104:107], v7, s[8:11], s44 offen offset:2048 sc1
    buffer_load_dwordx4 v[108:111], v8, s[8:11], s44 offen offset:2048 sc1
    s_add_u32 s44, s44, 4096
    s_waitcnt vmcnt(10) lgkmcnt(5)
    v_mfma_f32_16x16x32_bf16 v[16:19], v[56:59], v[112:115], v[16:19]
    v_mfma_f32_16x16x32_bf16 v[36:39], v[56:59], v[116:119], v[36:39]
    ds_read_b128 v[56:59], v4 offset:20480
    v_mfma_f32_16x16x32_bf16 v[20:23], v[60:63], v[112:115], v[20:23]
    v_mfma_f32_16x16x32_bf16 v[40:43], v[60:63], v[116:119], v[40:43]
    ds_read_b128 v[60:63], v4 offset:21504
    v_mfma_f32_16x16x32_bf16 v[24:27], v[64:67], v[112:115], v[24:27]
    v_mfma_f32_16x16x32_bf16 v[44:47], v[64:67], v[116:119], v[44:47]
    ds_read_b128 v[64:67], v4 offset:22528
    v_mfma_f32_16x16x32_bf16 v[28:31], v[68:71], v[112:115], v[28:31]
    v_mfma_f32_16x16x32_bf16 v[48:51], v[68:71], v[116:119], v[48:51]
    ds_read_b128 v[68:71], v4 offset:23552
    v_mfma_f32_16x16x32_bf16 v[32:35], v[72:75], v[112:115], v[32:35]
    v_mfma_f32_16x16x32_bf16 v[52:55], v[72:75], v[116:119], v[52:55]
    ds_read_b128 v[72:75], v4 offset:24576
    buffer_load_dwordx4 v[112:115], v7, s[8:11], s44 offen offset:0 sc1
    buffer_load_dwordx4 v[116:119], v8, s[8:11], s44 offen offset:0 sc1
    s_waitcnt vmcnt(10) lgkmcnt(5)
    v_mfma_f32_16x16x32_bf16 v[16:19], v[76:79], v[120:123], v[16:19]
    v_mfma_f32_16x16x32_bf16 v[36:39], v[76:79], v[124:127], v[36:39]
    ds_read_b128 v[76:79], v4 offset:30720
    v_mfma_f32_16x16x32_bf16 v[20:23], v[80:83], v[120:123], v[20:23]
    v_mfma_f32_16x16x32_bf16 v[40:43], v[80:83], v[124:127], v[40:43]
    ds_read_b128 v[80:83], v4 offset:31744
    v_mfma_f32_16x16x32_bf16 v[24:27], v[84:87], v[120:123], v[24:27]
    v_mfma_f32_16x16x32_bf16 v[44:47], v[84:87], v[124:127], v[44:47]
    ds_read_b128 v[84:87], v4 offset:32768
    v_mfma_f32_16x16x32_bf16 v[28:31], v[88:91], v[120:123], v[28:31]
    v_mfma_f32_16x16x32_bf16 v[48:51], v[88:91], v[124:127], v[48:51]
    ds_read_b128 v[88:91], v4 offset:33792
    v_mfma_f32_16x16x32_bf16 v[32:35], v[92:95], v[120:123], v[32:35]
    v_mfma_f32_16x16x32_bf16 v[52:55], v[92:95], v[124:127], v[52:55]
    ds_read_b128 v[92:95], v4 offset:34816
    v_add_u32 v4, 81920, v4
    v_subrev_u32 v14, 163840, v4
    v_min_u32 v4, v4, v14
    buffer_load_dwordx4 v[120:123], v7, s[8:11], s44 offen offset:2048 sc1
    buffer_load_dwordx4 v[124:127], v8, s[8:11], s44 offen offset:2048 sc1
    s_add_u32 s44, s44, 4096
    s_waitcnt vmcnt(10) lgkmcnt(5)
    v_mfma_f32_16x16x32_bf16 v[16:19], v[56:59], v[128:131], v[16:19]
    v_mfma_f32_16x16x32_bf16 v[36:39], v[56:59], v[132:135], v[36:39]
    ds_read_b128 v[56:59], v5 offset:0
    v_mfma_f32_16x16x32_bf16 v[20:23], v[60:63], v[128:131], v[20:23]
    v_mfma_f32_16x16x32_bf16 v[40:43], v[60:63], v[132:135], v[40:43]
    ds_read_b128 v[60:63], v5 offset:1024
    v_mfma_f32_16x16x32_bf16 v[24:27], v[64:67], v[128:131], v[24:27]
    v_mfma_f32_16x16x32_bf16 v[44:47], v[64:67], v[132:135], v[44:47]
    ds_read_b128 v[64:67], v5 offset:2048
    v_mfma_f32_16x16x32_bf16 v[28:31], v[68:71], v[128:131], v[28:31]
    v_mfma_f32_16x16x32_bf16 v[48:51], v[68:71], v[132:135], v[48:51]
    ds_read_b128 v[68:71], v5 offset:3072
    v_mfma_f32_16x16x32_bf16 v[32:35], v[72:75], v[128:131], v[32:35]
    v_mfma_f32_16x16x32_bf16 v[52:55], v[72:75], v[132:135], v[52:55]
    ds_read_b128 v[72:75], v5 offset:4096
    buffer_load_dwordx4 v[128:131], v7, s[8:11], s44 offen offset:0 sc1
    buffer_load_dwordx4 v[132:135], v8, s[8:11], s44 offen offset:0 sc1
    s_waitcnt vmcnt(10) lgkmcnt(5)
    v_mfma_f32_16x16x32_bf16 v[16:19], v[76:79], v[136:139], v[16:19]
    v_mfma_f32_16x16x32_bf16 v[36:39], v[76:79], v[140:143], v[36:39]
    ds_read_b128 v[76:79], v5 offset:10240
    v_mfma_f32_16x16x32_bf16 v[20:23], v[80:83], v[136:139], v[20:23]
    v_mfma_f32_16x16x32_bf16 v[40:43], v[80:83], v[140:143], v[40:43]
    ds_read_b128 v[80:83], v5 offset:11264
    v_mfma_f32_16x16x32_bf16 v[24:27], v[84:87], v[136:139], v[24:27]
    v_mfma_f32_16x16x32_bf16 v[44:47], v[84:87], v[140:143], v[44:47]
    ds_read_b128 v[84:87], v5 offset:12288
    v_mfma_f32_16x16x32_bf16 v[28:31], v[88:91], v[136:139], v[28:31]
    v_mfma_f32_16x16x32_bf16 v[48:51], v[88:91], v[140:143], v[48:51]
    ds_read_b128 v[88:91], v5 offset:13312
    v_mfma_f32_16x16x32_bf16 v[32:35], v[92:95], v[136:139], v[32:35]
    v_mfma_f32_16x16x32_bf16 v[52:55], v[92:95], v[140:143], v[52:55]
    ds_read_b128 v[92:95], v5 offset:14336
    buffer_load_dwordx4 v[136:139], v7, s[8:11], s44 offen offset:2048 sc1
    buffer_load_dwordx4 v[140:143], v8, s[8:11], s44 offen offset:2048 sc1
    s_add_u32 s44, s44, 4096
    v_swap_b32 v4, v5
    s_waitcnt vmcnt(10) lgkmcnt(5)
    v_mfma_f32_16x16x32_bf16 v[16:19], v[56:59], v[96:99], v[16:19]
    v_mfma_f32_16x16x32_bf16 v[36:39], v[56:59], v[100:103], v[36:39]
    ds_read_b128 v[56:59], v4 offset:20480
    v_mfma_f32_16x16x32_bf16 v[20:23], v[60:63], v[96:99], v[20:23]
    v_mfma_f32_16x16x32_bf16 v[40:43], v[60:63], v[100:103], v[40:43]
    ds_read_b128 v[60:63], v4 offset:21504
    v_mfma_f32_16x16x32_bf16 v[24:27], v[64:67], v[96:99], v[24:27]
    v_mfma_f32_16x16x32_bf16 v[44:47], v[64:67], v[100:103], v[44:47]
    ds_read_b128 v[64:67], v4 offset:22528
    v_mfma_f32_16x16x32_bf16 v[28:31], v[68:71], v[96:99], v[28:31]
    v_mfma_f32_16x16x32_bf16 v[48:51], v[68:71], v[100:103], v[48:51]
    ds_read_b128 v[68:71], v4 offset:23552
    v_mfma_f32_16x16x32_bf16 v[32:35], v[72:75], v[96:99], v[32:35]
    v_mfma_f32_16x16x32_bf16 v[52:55], v[72:75], v[100:103], v[52:55]
    ds_read_b128 v[72:75], v4 offset:24576
    buffer_load_dwordx4 v[96:99], v7, s[8:11], s44 offen offset:0 sc1
    buffer_load_dwordx4 v[100:103], v8, s[8:11], s44 offen offset:0 sc1
    s_waitcnt vmcnt(10) lgkmcnt(5)
    v_mfma_f32_16x16x32_bf16 v[16:19], v[76:79], v[104:107], v[16:19]
    v_mfma_f32_16x16x32_bf16 v[36:39], v[76:79], v[108:111], v[36:39]
    ds_read_b128 v[76:79], v4 offset:30720
    v_mfma_f32_16x16x32_bf16 v[20:23], v[80:83], v[104:107], v[20:23]
    v_mfma_f32_16x16x32_bf16 v[40:43], v[80:83], v[108:111], v[40:43]
    ds_read_b128 v[80:83], v4 offset:31744
    v_mfma_f32_16x16x32_bf16 v[24:27], v[84:87], v[104:107], v[24:27]
    v_mfma_f32_16x16x32_bf16 v[44:47], v[84:87], v[108:111], v[44:47]
    ds_read_b128 v[84:87], v4 offset:32768
    v_mfma_f32_16x16x32_bf16 v[28:31], v[88:91], v[104:107], v[28:31]
    v_mfma_f32_16x16x32_bf16 v[48:51], v[88:91], v[108:111], v[48:51]
    ds_read_b128 v[88:91], v4 offset:33792
    v_mfma_f32_16x16x32_bf16 v[32:35], v[92:95], v[104:107], v[32:35]
    v_mfma_f32_16x16x32_bf16 v[52:55], v[92:95], v[108:111], v[52:55]
    ds_read_b128 v[92:95], v4 offset:34816
    v_add_u32 v4, 81920, v4
    v_subrev_u32 v14, 163840, v4
    v_min_u32 v4, v4, v14
    buffer_load_dwordx4 v[104:107], v7, s[8:11], s44 offen offset:2048 sc1
    buffer_load_dwordx4 v[108:111], v8, s[8:11], s44 offen offset:2048 sc1
    s_add_u32 s44, s44, 4096
    s_waitcnt vmcnt(10) lgkmcnt(5)
    s_barrier
    v_mfma_f32_16x16x32_bf16 v[16:19], v[56:59], v[112:115], v[16:19]
    v_mfma_f32_16x16x32_bf16 v[36:39], v[56:59], v[116:119], v[36:39]
    ds_read_b128 v[56:59], v5 offset:0
    v_mfma_f32_16x16x32_bf16 v[20:23], v[60:63], v[112:115], v[20:23]
    v_mfma_f32_16x16x32_bf16 v[40:43], v[60:63], v[116:119], v[40:43]
    ds_read_b128 v[60:63], v5 offset:1024
    v_mfma_f32_16x16x32_bf16 v[24:27], v[64:67], v[112:115], v[24:27]
    v_mfma_f32_16x16x32_bf16 v[44:47], v[64:67], v[116:119], v[44:47]
    ds_read_b128 v[64:67], v5 offset:2048
    v_mfma_f32_16x16x32_bf16 v[28:31], v[68:71], v[112:115], v[28:31]
    v_mfma_f32_16x16x32_bf16 v[48:51], v[68:71], v[116:119], v[48:51]
    ds_read_b128 v[68:71], v5 offset:3072
    v_mfma_f32_16x16x32_bf16 v[32:35], v[72:75], v[112:115], v[32:35]
    v_mfma_f32_16x16x32_bf16 v[52:55], v[72:75], v[116:119], v[52:55]
    ds_read_b128 v[72:75], v5 offset:4096
    buffer_load_dwordx4 v[112:115], v7, s[8:11], s44 offen offset:0 sc1
    buffer_load_dwordx4 v[116:119], v8, s[8:11], s44 offen offset:0 sc1
    s_waitcnt vmcnt(10) lgkmcnt(5)
    v_mfma_f32_16x16x32_bf16 v[16:19], v[76:79], v[120:123], v[16:19]
    v_mfma_f32_16x16x32_bf16 v[36:39], v[76:79], v[124:127], v[36:39]
    ds_read_b128 v[76:79], v5 offset:10240
    v_mfma_f32_16x16x32_bf16 v[20:23], v[80:83], v[120:123], v[20:23]
    v_mfma_f32_16x16x32_bf16 v[40:43], v[80:83], v[124:127], v[40:43]
    ds_read_b128 v[80:83], v5 offset:11264
    v_mfma_f32_16x16x32_bf16 v[24:27], v[84:87], v[120:123], v[24:27]
    v_mfma_f32_16x16x32_bf16 v[44:47], v[84:87], v[124:127], v[44:47]
    ds_read_b128 v[84:87], v5 offset:12288
    v_mfma_f32_16x16x32_bf16 v[28:31], v[88:91], v[120:123], v[28:31]
    v_mfma_f32_16x16x32_bf16 v[48:51], v[88:91], v[124:127], v[48:51]
    ds_read_b128 v[88:91], v5 offset:13312
    v_mfma_f32_16x16x32_bf16 v[32:35], v[92:95], v[120:123], v[32:35]
    v_mfma_f32_16x16x32_bf16 v[52:55], v[92:95], v[124:127], v[52:55]
    ds_read_b128 v[92:95], v5 offset:14336
    buffer_load_dwordx4 v[120:123], v7, s[8:11], s44 offen offset:2048 sc1
    buffer_load_dwordx4 v[124:127], v8, s[8:11], s44 offen offset:2048 sc1
    s_add_u32 s44, s44, 4096
    s_waitcnt vmcnt(10) lgkmcnt(5)
    v_mfma_f32_16x16x32_bf16 v[16:19], v[56:59], v[128:131], v[16:19]
    v_mfma_f32_16x16x32_bf16 v[36:39], v[56:59], v[132:135], v[36:39]
    ds_read_b128 v[56:59], v5 offset:20480
    v_mfma_f32_16x16x32_bf16 v[20:23], v[60:63], v[128:131], v[20:23]
    v_mfma_f32_16x16x32_bf16 v[40:43], v[60:63], v[132:135], v[40:43]
    ds_read_b128 v[60:63], v5 offset:21504
    v_mfma_f32_16x16x32_bf16 v[24:27], v[64:67], v[128:131], v[24:27]
    v_mfma_f32_16x16x32_bf16 v[44:47], v[64:67], v[132:135], v[44:47]
    ds_read_b128 v[64:67], v5 offset:22528
    v_mfma_f32_16x16x32_bf16 v[28:31], v[68:71], v[128:131], v[28:31]
    v_mfma_f32_16x16x32_bf16 v[48:51], v[68:71], v[132:135], v[48:51]
    ds_read_b128 v[68:71], v5 offset:23552
    v_mfma_f32_16x16x32_bf16 v[32:35], v[72:75], v[128:131], v[32:35]
    v_mfma_f32_16x16x32_bf16 v[52:55], v[72:75], v[132:135], v[52:55]
    ds_read_b128 v[72:75], v5 offset:24576
    buffer_load_dwordx4 v[128:131], v7, s[8:11], s44 offen offset:0 sc1
    buffer_load_dwordx4 v[132:135], v8, s[8:11], s44 offen offset:0 sc1
    s_waitcnt vmcnt(10) lgkmcnt(5)
    v_mfma_f32_16x16x32_bf16 v[16:19], v[76:79], v[136:139], v[16:19]
    v_mfma_f32_16x16x32_bf16 v[36:39], v[76:79], v[140:143], v[36:39]
    ds_read_b128 v[76:79], v5 offset:30720
    v_mfma_f32_16x16x32_bf16 v[20:23], v[80:83], v[136:139], v[20:23]
    v_mfma_f32_16x16x32_bf16 v[40:43], v[80:83], v[140:143], v[40:43]
    ds_read_b128 v[80:83], v5 offset:31744
    v_mfma_f32_16x16x32_bf16 v[24:27], v[84:87], v[136:139], v[24:27]
    v_mfma_f32_16x16x32_bf16 v[44:47], v[84:87], v[140:143], v[44:47]
    ds_read_b128 v[84:87], v5 offset:32768
    v_mfma_f32_16x16x32_bf16 v[28:31], v[88:91], v[136:139], v[28:31]
    v_mfma_f32_16x16x32_bf16 v[48:51], v[88:91], v[140:143], v[48:51]
    ds_read_b128 v[88:91], v5 offset:33792
    v_mfma_f32_16x16x32_bf16 v[32:35], v[92:95], v[136:139], v[32:35]
    v_mfma_f32_16x16x32_bf16 v[52:55], v[92:95], v[140:143], v[52:55]
    ds_read_b128 v[92:95], v5 offset:34816
    v_add_u32 v5, 81920, v5
    v_subrev_u32 v14, 163840, v5
    v_min_u32 v5, v5, v14
    buffer_load_dwordx4 v[136:139], v7, s[8:11], s44 offen offset:2048 sc1
    buffer_load_dwordx4 v[140:143], v8, s[8:11], s44 offen offset:2048 sc1
    s_add_u32 s44, s44, 4096
    s_waitcnt vmcnt(10) lgkmcnt(5)
    s_barrier
    v_mfma_f32_16x16x32_bf16 v[16:19], v[56:59], v[96:99], v[16:19]
    v_mfma_f32_16x16x32_bf16 v[36:39], v[56:59], v[100:103], v[36:39]
    ds_read_b128 v[56:59], v4 offset:0
    v_mfma_f32_16x16x32_bf16 v[20:23], v[60:63], v[96:99], v[20:23]
    v_mfma_f32_16x16x32_bf16 v[40:43], v[60:63], v[100:103], v[40:43]
    ds_read_b128 v[60:63], v4 offset:1024
    v_mfma_f32_16x16x32_bf16 v[24:27], v[64:67], v[96:99], v[24:27]
    v_mfma_f32_16x16x32_bf16 v[44:47], v[64:67], v[100:103], v[44:47]
    ds_read_b128 v[64:67], v4 offset:2048
    v_mfma_f32_16x16x32_bf16 v[28:31], v[68:71], v[96:99], v[28:31]
    v_mfma_f32_16x16x32_bf16 v[48:51], v[68:71], v[100:103], v[48:51]
    ds_read_b128 v[68:71], v4 offset:3072
    v_mfma_f32_16x16x32_bf16 v[32:35], v[72:75], v[96:99], v[32:35]
    v_mfma_f32_16x16x32_bf16 v[52:55], v[72:75], v[100:103], v[52:55]
    ds_read_b128 v[72:75], v4 offset:4096
    s_waitcnt vmcnt(8) lgkmcnt(5)
    v_mfma_f32_16x16x32_bf16 v[16:19], v[76:79], v[104:107], v[16:19]
    v_mfma_f32_16x16x32_bf16 v[36:39], v[76:79], v[108:111], v[36:39]
    ds_read_b128 v[76:79], v4 offset:10240
    v_mfma_f32_16x16x32_bf16 v[20:23], v[80:83], v[104:107], v[20:23]
    v_mfma_f32_16x16x32_bf16 v[40:43], v[80:83], v[108:111], v[40:43]
    ds_read_b128 v[80:83], v4 offset:11264
    v_mfma_f32_16x16x32_bf16 v[24:27], v[84:87], v[104:107], v[24:27]
    v_mfma_f32_16x16x32_bf16 v[44:47], v[84:87], v[108:111], v[44:47]
    ds_read_b128 v[84:87], v4 offset:12288
    v_mfma_f32_16x16x32_bf16 v[28:31], v[88:91], v[104:107], v[28:31]
    v_mfma_f32_16x16x32_bf16 v[48:51], v[88:91], v[108:111], v[48:51]
    ds_read_b128 v[88:91], v4 offset:13312
    v_mfma_f32_16x16x32_bf16 v[32:35], v[92:95], v[104:107], v[32:35]
    v_mfma_f32_16x16x32_bf16 v[52:55], v[92:95], v[108:111], v[52:55]
    ds_read_b128 v[92:95], v4 offset:14336
    s_waitcnt vmcnt(6) lgkmcnt(5)
    v_mfma_f32_16x16x32_bf16 v[16:19], v[56:59], v[112:115], v[16:19]
    v_mfma_f32_16x16x32_bf16 v[36:39], v[56:59], v[116:119], v[36:39]
    ds_read_b128 v[56:59], v4 offset:20480
    v_mfma_f32_16x16x32_bf16 v[20:23], v[60:63], v[112:115], v[20:23]
    v_mfma_f32_16x16x32_bf16 v[40:43], v[60:63], v[116:119], v[40:43]
    ds_read_b128 v[60:63], v4 offset:21504
    v_mfma_f32_16x16x32_bf16 v[24:27], v[64:67], v[112:115], v[24:27]
    v_mfma_f32_16x16x32_bf16 v[44:47], v[64:67], v[116:119], v[44:47]
    ds_read_b128 v[64:67], v4 offset:22528
    v_mfma_f32_16x16x32_bf16 v[28:31], v[68:71], v[112:115], v[28:31]
    v_mfma_f32_16x16x32_bf16 v[48:51], v[68:71], v[116:119], v[48:51]
    ds_read_b128 v[68:71], v4 offset:23552
    v_mfma_f32_16x16x32_bf16 v[32:35], v[72:75], v[112:115], v[32:35]
    v_mfma_f32_16x16x32_bf16 v[52:55], v[72:75], v[116:119], v[52:55]
    ds_read_b128 v[72:75], v4 offset:24576
    s_waitcnt vmcnt(4) lgkmcnt(5)
    v_mfma_f32_16x16x32_bf16 v[16:19], v[76:79], v[120:123], v[16:19]
    v_mfma_f32_16x16x32_bf16 v[36:39], v[76:79], v[124:127], v[36:39]
    ds_read_b128 v[76:79], v4 offset:30720
    v_mfma_f32_16x16x32_bf16 v[20:23], v[80:83], v[120:123], v[20:23]
    v_mfma_f32_16x16x32_bf16 v[40:43], v[80:83], v[124:127], v[40:43]
    ds_read_b128 v[80:83], v4 offset:31744
    v_mfma_f32_16x16x32_bf16 v[24:27], v[84:87], v[120:123], v[24:27]
    v_mfma_f32_16x16x32_bf16 v[44:47], v[84:87], v[124:127], v[44:47]
    ds_read_b128 v[84:87], v4 offset:32768
    v_mfma_f32_16x16x32_bf16 v[28:31], v[88:91], v[120:123], v[28:31]
    v_mfma_f32_16x16x32_bf16 v[48:51], v[88:91], v[124:127], v[48:51]
    ds_read_b128 v[88:91], v4 offset:33792
    v_mfma_f32_16x16x32_bf16 v[32:35], v[92:95], v[120:123], v[32:35]
    v_mfma_f32_16x16x32_bf16 v[52:55], v[92:95], v[124:127], v[52:55]
    ds_read_b128 v[92:95], v4 offset:34816
    v_add_u32 v4, 81920, v4
    v_subrev_u32 v14, 163840, v4
    v_min_u32 v4, v4, v14
    s_waitcnt vmcnt(2) lgkmcnt(5)
    v_mfma_f32_16x16x32_bf16 v[36:39], v[56:59], v[132:135], v[36:39]
    v_mfma_f32_16x16x32_bf16 v[40:43], v[60:63], v[132:135], v[40:43]
    v_mfma_f32_16x16x32_bf16 v[44:47], v[64:67], v[132:135], v[44:47]
    v_mfma_f32_16x16x32_bf16 v[48:51], v[68:71], v[132:135], v[48:51]
    v_mfma_f32_16x16x32_bf16 v[52:55], v[72:75], v[132:135], v[52:55]
    s_mul_i32 s42, s20, 5120
    s_add_u32 s42, s42, 81920
    v_lshl_add_u32 v10, v0, 4, s42
    s_xor_b32 s43, s20, 1
    s_mul_i32 s43, s43, 5120
    s_add_u32 s43, s43, 81920
    v_lshl_add_u32 v9, v0, 4, s43
    s_waitcnt vmcnt(0) lgkmcnt(0)
    v_mfma_f32_16x16x32_bf16 v[36:39], v[76:79], v[140:143], v[36:39]
    v_mfma_f32_16x16x32_bf16 v[40:43], v[80:83], v[140:143], v[40:43]
    v_mfma_f32_16x16x32_bf16 v[44:47], v[84:87], v[140:143], v[44:47]
    v_mfma_f32_16x16x32_bf16 v[48:51], v[88:91], v[140:143], v[48:51]
    v_mfma_f32_16x16x32_bf16 v[52:55], v[92:95], v[140:143], v[52:55]
    v_mfma_f32_16x16x32_bf16 v[16:19], v[56:59], v[128:131], v[16:19]
    v_mfma_f32_16x16x32_bf16 v[20:23], v[60:63], v[128:131], v[20:23]
    v_mfma_f32_16x16x32_bf16 v[24:27], v[64:67], v[128:131], v[24:27]
    v_mfma_f32_16x16x32_bf16 v[28:31], v[68:71], v[128:131], v[28:31]
    v_mfma_f32_16x16x32_bf16 v[32:35], v[72:75], v[128:131], v[32:35]
    ds_write_b128 v9, v[36:39] offset:0
    v_mfma_f32_16x16x32_bf16 v[16:19], v[76:79], v[136:139], v[16:19]
    ds_write_b128 v9, v[40:43] offset:1024
    v_mfma_f32_16x16x32_bf16 v[20:23], v[80:83], v[136:139], v[20:23]
    ds_write_b128 v9, v[44:47] offset:2048
    v_mfma_f32_16x16x32_bf16 v[24:27], v[84:87], v[136:139], v[24:27]
    ds_write_b128 v9, v[48:51] offset:3072
    v_mfma_f32_16x16x32_bf16 v[28:31], v[88:91], v[136:139], v[28:31]
    ds_write_b128 v9, v[52:55] offset:4096
    v_mfma_f32_16x16x32_bf16 v[32:35], v[92:95], v[136:139], v[32:35]
    s_mov_b32 s12, s70
    s_and_b32 s13, s71, 0xffff
    s_mov_b32 s14, 2621440
    s_mov_b32 s15, 0x20000
    v_mul_u32_u24 v11, 1280, v2
    v_lshrrev_b32 v14, 1, v3
    v_lshl_add_u32 v15, v14, 4, v11
    v_and_b32 v14, 1, v3
    v_lshl_add_u32 v12, v14, 5, v15
    s_lshl_b32 s44, s72, 2
    s_add_u32 s44, s44, s76
    s_mul_i32 s44, s44, 20480
    s_mul_i32 s43, s73, 160
    s_add_u32 s44, s44, s43
    v_pk_add_f32 v[148:149], v[148:149], v[16:17]
    v_pk_add_f32 v[150:151], v[150:151], v[18:19]
    v_pk_add_f32 v[152:153], v[152:153], v[20:21]
    v_pk_add_f32 v[154:155], v[154:155], v[22:23]
    v_pk_add_f32 v[156:157], v[156:157], v[24:25]
    v_pk_add_f32 v[158:159], v[158:159], v[26:27]
    v_pk_add_f32 v[160:161], v[160:161], v[28:29]
    v_pk_add_f32 v[162:163], v[162:163], v[30:31]
    v_pk_add_f32 v[164:165], v[164:165], v[32:33]
    v_pk_add_f32 v[166:167], v[166:167], v[34:35]
    s_waitcnt lgkmcnt(0)
    s_barrier
    ds_read_b128 v[56:59], v10 offset:0
    ds_read_b128 v[60:63], v10 offset:1024
    ds_read_b128 v[64:67], v10 offset:2048
    ds_read_b128 v[68:71], v10 offset:3072
    ds_read_b128 v[72:75], v10 offset:4096
    s_waitcnt lgkmcnt(4)
    v_pk_add_f32 v[148:149], v[148:149], v[56:57]
    v_pk_add_f32 v[150:151], v[150:151], v[58:59]
    v_cvt_pk_bf16_f32 v76, v148, v149
    v_cvt_pk_bf16_f32 v77, v150, v151
    s_waitcnt lgkmcnt(3)
    v_pk_add_f32 v[152:153], v[152:153], v[60:61]
    v_pk_add_f32 v[154:155], v[154:155], v[62:63]
    v_cvt_pk_bf16_f32 v78, v152, v153
    v_cvt_pk_bf16_f32 v79, v154, v155
    s_waitcnt lgkmcnt(2)
    v_pk_add_f32 v[156:157], v[156:157], v[64:65]
    v_pk_add_f32 v[158:159], v[158:159], v[66:67]
    v_cvt_pk_bf16_f32 v80, v156, v157
    v_cvt_pk_bf16_f32 v81, v158, v159
    s_waitcnt lgkmcnt(1)
    v_pk_add_f32 v[160:161], v[160:161], v[68:69]
    v_pk_add_f32 v[162:163], v[162:163], v[70:71]
    v_cvt_pk_bf16_f32 v82, v160, v161
    v_cvt_pk_bf16_f32 v83, v162, v163
    s_waitcnt lgkmcnt(0)
    v_pk_add_f32 v[164:165], v[164:165], v[72:73]
    v_pk_add_f32 v[166:167], v[166:167], v[74:75]
    v_cvt_pk_bf16_f32 v84, v164, v165
    v_cvt_pk_bf16_f32 v85, v166, v167
    v_mov_b32 v86, v84
    v_mov_b32 v87, v85
    v_permlane16_swap_b32 v76, v78
    v_permlane16_swap_b32 v77, v79
    v_permlane16_swap_b32 v80, v82
    v_permlane16_swap_b32 v81, v83
    v_permlane16_swap_b32 v84, v86
    v_permlane16_swap_b32 v85, v87
    buffer_store_dwordx4 v[76:79], v12, s[12:15], s44 offen offset:0
    buffer_store_dwordx4 v[80:83], v12, s[12:15], s44 offen offset:64
    s_mov_b32 exec_lo, 0xffff
    s_mov_b32 exec_hi, 0xffff
    buffer_store_dwordx4 v[84:87], v15, s[12:15], s44 offen offset:128
    s_mov_b64 exec, -1
sequential_preLN__mha_block__glu_gated_geglu__prompt_kernel_done:
sequential_preLN__mha_block__glu_gated_geglu__prompt_kernel_exit:
    s_endpgm
sequential_preLN__mha_block__glu_gated_geglu__prompt_kernel_p4_scalar:
    v_mul_f32 v64, v16, v16
    v_mul_f32 v65, v17, v17
    v_mul_f32 v66, v18, v18
    v_mul_f32 v67, v19, v19
    v_mul_f32 v68, v20, v20
    v_mul_f32 v69, v21, v21
    v_mul_f32 v70, v22, v22
    v_mul_f32 v71, v23, v23
    v_fma_f32 v64, v64, v136, v134
    v_fma_f32 v65, v65, v136, v134
    v_fma_f32 v66, v66, v136, v134
    v_fma_f32 v67, v67, v136, v134
    v_fma_f32 v68, v68, v137, v135
    v_fma_f32 v69, v69, v137, v135
    v_fma_f32 v70, v70, v137, v135
    v_fma_f32 v71, v71, v137, v135
    v_mul_f32 v64, v64, v16
    v_mul_f32 v65, v65, v17
    v_mul_f32 v66, v66, v18
    v_mul_f32 v67, v67, v19
    v_mul_f32 v68, v68, v20
    v_mul_f32 v69, v69, v21
    v_mul_f32 v70, v70, v22
    v_mul_f32 v71, v71, v23
    v_exp_f32 v64, v64
    v_exp_f32 v65, v65
    v_exp_f32 v66, v66
    v_exp_f32 v67, v67
    v_exp_f32 v68, v68
    v_exp_f32 v69, v69
    v_exp_f32 v70, v70
    v_exp_f32 v71, v71
    v_mul_f32 v16, v16, v40
    v_mul_f32 v17, v17, v41
    v_mul_f32 v18, v18, v42
    v_mul_f32 v19, v19, v43
    v_mul_f32 v20, v20, v44
    v_mul_f32 v21, v21, v45
    v_mul_f32 v22, v22, v46
    v_mul_f32 v23, v23, v47
    v_fma_f32 v64, v64, v132, v132
    v_fma_f32 v65, v65, v132, v132
    v_fma_f32 v66, v66, v132, v132
    v_fma_f32 v67, v67, v132, v132
    v_fma_f32 v68, v68, v133, v133
    v_fma_f32 v69, v69, v133, v133
    v_fma_f32 v70, v70, v133, v133
    v_fma_f32 v71, v71, v133, v133
    v_rcp_f32 v64, v64
    v_rcp_f32 v65, v65
    v_rcp_f32 v66, v66
    v_rcp_f32 v67, v67
    v_rcp_f32 v68, v68
    v_rcp_f32 v69, v69
    v_rcp_f32 v70, v70
    v_rcp_f32 v71, v71
    s_nop 0
    v_mul_f32 v16, v16, v64
    v_mul_f32 v17, v17, v65
    v_mul_f32 v18, v18, v66
    v_mul_f32 v19, v19, v67
    v_mul_f32 v20, v20, v68
    v_mul_f32 v21, v21, v69
    v_mul_f32 v22, v22, v70
    v_mul_f32 v23, v23, v71
    v_cvt_pk_bf16_f32 v72, v16, v17
    v_cvt_pk_bf16_f32 v73, v18, v19
    v_cvt_pk_bf16_f32 v74, v20, v21
    v_cvt_pk_bf16_f32 v75, v22, v23
    s_nop 1
    v_permlane16_swap_b32 v72, v74
    v_permlane16_swap_b32 v73, v75
    buffer_store_dwordx4 v[72:75], v1, s[8:11], s50 offen offset:0 sc1
    v_mul_f32 v64, v24, v24
    v_mul_f32 v65, v25, v25
    v_mul_f32 v66, v26, v26
    v_mul_f32 v67, v27, v27
    v_mul_f32 v68, v28, v28
    v_mul_f32 v69, v29, v29
    v_mul_f32 v70, v30, v30
    v_mul_f32 v71, v31, v31
    v_fma_f32 v64, v64, v136, v134
    v_fma_f32 v65, v65, v136, v134
    v_fma_f32 v66, v66, v136, v134
    v_fma_f32 v67, v67, v136, v134
    v_fma_f32 v68, v68, v137, v135
    v_fma_f32 v69, v69, v137, v135
    v_fma_f32 v70, v70, v137, v135
    v_fma_f32 v71, v71, v137, v135
    v_mul_f32 v64, v64, v24
    v_mul_f32 v65, v65, v25
    v_mul_f32 v66, v66, v26
    v_mul_f32 v67, v67, v27
    v_mul_f32 v68, v68, v28
    v_mul_f32 v69, v69, v29
    v_mul_f32 v70, v70, v30
    v_mul_f32 v71, v71, v31
    v_exp_f32 v64, v64
    v_exp_f32 v65, v65
    v_exp_f32 v66, v66
    v_exp_f32 v67, v67
    v_exp_f32 v68, v68
    v_exp_f32 v69, v69
    v_exp_f32 v70, v70
    v_exp_f32 v71, v71
    v_mul_f32 v24, v24, v48
    v_mul_f32 v25, v25, v49
    v_mul_f32 v26, v26, v50
    v_mul_f32 v27, v27, v51
    v_mul_f32 v28, v28, v52
    v_mul_f32 v29, v29, v53
    v_mul_f32 v30, v30, v54
    v_mul_f32 v31, v31, v55
    v_fma_f32 v64, v64, v132, v132
    v_fma_f32 v65, v65, v132, v132
    v_fma_f32 v66, v66, v132, v132
    v_fma_f32 v67, v67, v132, v132
    v_fma_f32 v68, v68, v133, v133
    v_fma_f32 v69, v69, v133, v133
    v_fma_f32 v70, v70, v133, v133
    v_fma_f32 v71, v71, v133, v133
    v_rcp_f32 v64, v64
    v_rcp_f32 v65, v65
    v_rcp_f32 v66, v66
    v_rcp_f32 v67, v67
    v_rcp_f32 v68, v68
    v_rcp_f32 v69, v69
    v_rcp_f32 v70, v70
    v_rcp_f32 v71, v71
    s_nop 0
    v_mul_f32 v24, v24, v64
    v_mul_f32 v25, v25, v65
    v_mul_f32 v26, v26, v66
    v_mul_f32 v27, v27, v67
    v_mul_f32 v28, v28, v68
    v_mul_f32 v29, v29, v69
    v_mul_f32 v30, v30, v70
    v_mul_f32 v31, v31, v71
    v_cvt_pk_bf16_f32 v76, v24, v25
    v_cvt_pk_bf16_f32 v77, v26, v27
    v_cvt_pk_bf16_f32 v78, v28, v29
    v_cvt_pk_bf16_f32 v79, v30, v31
    s_nop 1
    v_permlane16_swap_b32 v76, v78
    v_permlane16_swap_b32 v77, v79
    buffer_store_dwordx4 v[76:79], v1, s[8:11], s50 offen offset:1024 sc1
    v_mul_f32 v64, v32, v32
    v_mul_f32 v65, v33, v33
    v_mul_f32 v66, v34, v34
    v_mul_f32 v67, v35, v35
    v_mul_f32 v68, v36, v36
    v_mul_f32 v69, v37, v37
    v_mul_f32 v70, v38, v38
    v_mul_f32 v71, v39, v39
    v_fma_f32 v64, v64, v136, v134
    v_fma_f32 v65, v65, v136, v134
    v_fma_f32 v66, v66, v136, v134
    v_fma_f32 v67, v67, v136, v134
    v_fma_f32 v68, v68, v137, v135
    v_fma_f32 v69, v69, v137, v135
    v_fma_f32 v70, v70, v137, v135
    v_fma_f32 v71, v71, v137, v135
    v_mul_f32 v64, v64, v32
    v_mul_f32 v65, v65, v33
    v_mul_f32 v66, v66, v34
    v_mul_f32 v67, v67, v35
    v_mul_f32 v68, v68, v36
    v_mul_f32 v69, v69, v37
    v_mul_f32 v70, v70, v38
    v_mul_f32 v71, v71, v39
    v_exp_f32 v64, v64
    v_exp_f32 v65, v65
    v_exp_f32 v66, v66
    v_exp_f32 v67, v67
    v_exp_f32 v68, v68
    v_exp_f32 v69, v69
    v_exp_f32 v70, v70
    v_exp_f32 v71, v71
    v_mul_f32 v32, v32, v56
    v_mul_f32 v33, v33, v57
    v_mul_f32 v34, v34, v58
    v_mul_f32 v35, v35, v59
    v_mul_f32 v36, v36, v60
    v_mul_f32 v37, v37, v61
    v_mul_f32 v38, v38, v62
    v_mul_f32 v39, v39, v63
    v_fma_f32 v64, v64, v132, v132
    v_fma_f32 v65, v65, v132, v132
    v_fma_f32 v66, v66, v132, v132
    v_fma_f32 v67, v67, v132, v132
    v_fma_f32 v68, v68, v133, v133
    v_fma_f32 v69, v69, v133, v133
    v_fma_f32 v70, v70, v133, v133
    v_fma_f32 v71, v71, v133, v133
    v_rcp_f32 v64, v64
    v_rcp_f32 v65, v65
    v_rcp_f32 v66, v66
    v_rcp_f32 v67, v67
    v_rcp_f32 v68, v68
    v_rcp_f32 v69, v69
    v_rcp_f32 v70, v70
    v_rcp_f32 v71, v71
    s_nop 0
    v_mul_f32 v32, v32, v64
    v_mul_f32 v33, v33, v65
    v_mul_f32 v34, v34, v66
    v_mul_f32 v35, v35, v67
    v_mul_f32 v36, v36, v68
    v_mul_f32 v37, v37, v69
    v_mul_f32 v38, v38, v70
    v_mul_f32 v39, v39, v71
    v_cvt_pk_bf16_f32 v80, v32, v33
    v_cvt_pk_bf16_f32 v81, v34, v35
    v_cvt_pk_bf16_f32 v82, v36, v37
    v_cvt_pk_bf16_f32 v83, v38, v39
    s_nop 1
    v_permlane16_swap_b32 v80, v82
    v_permlane16_swap_b32 v81, v83
    buffer_store_dwordx4 v[80:83], v1, s[8:11], s50 offen offset:2048 sc1
    s_branch sequential_preLN__mha_block__glu_gated_geglu__prompt_kernel_p4_gelu_done
sequential_preLN__mha_block__glu_gated_geglu__prompt_kernel_p4_stats:
    v_add_f32 v128, v128, v129
    v_mov_b32 v129, v128
    v_add_f32 v130, v130, v131
    v_mov_b32 v131, v130
    s_nop 0
    v_permlane32_swap_b32 v128, v129
    v_add_f32 v128, v128, v129
    v_mov_b32 v129, v128
    v_permlane32_swap_b32 v130, v131
    v_add_f32 v130, v130, v131
    v_mov_b32 v131, v130
    s_nop 0
    v_permlane16_swap_b32 v128, v129
    v_add_f32 v128, v128, v129
    v_mov_b32 v132, 0x3727c5ac
    v_fmac_f32 v132, 0x3acccccd, v128
    v_rsq_f32 v128, v132
    s_nop 0
    v_mul_f32 v134, 0xc0135761, v128
    v_mul_f32 v128, v128, v128
    v_mul_f32 v128, 0x3d372713, v128
    v_mul_f32 v136, v134, v128
    v_permlane16_swap_b32 v130, v131
    v_add_f32 v130, v130, v131
    v_mov_b32 v133, 0x3727c5ac
    v_fmac_f32 v133, 0x3acccccd, v130
    v_rsq_f32 v130, v133
    s_nop 0
    v_mul_f32 v135, 0xc0135761, v130
    v_mul_f32 v130, v130, v130
    v_mul_f32 v130, 0x3d372713, v130
    v_mul_f32 v137, v135, v130
    s_branch sequential_preLN__mha_block__glu_gated_geglu__prompt_kernel_p4_statsback
sequential_preLN__mha_block__glu_gated_geglu__prompt_kernel_helpers:
    s_load_dwordx2 s[36:37], s[0:1], 64
    s_mov_b32 s12, s40
    s_and_b32 s13, s41, 0xffff
    s_mov_b32 s14, 2621440
    s_mov_b32 s15, 0x20000
    s_cmp_ge_u32 s20, 6
    s_cbranch_scc1 sequential_preLN__mha_block__glu_gated_geglu__prompt_kernel_hidle
    s_lshl_b32 s32, s21, 5
    s_lshl_b32 s33, s22, 1
    s_add_u32 s32, s32, s33
    s_add_u32 s32, s32, s20
    s_sub_u32 s32, s32, 4
    s_mul_i32 s33, s32, 5120
    v_lshrrev_b32 v9, 4, v0
    v_mul_u32_u24 v3, 1280, v9
    v_and_b32 v2, 15, v0
    v_lshl_add_u32 v3, v2, 4, v3
    v_lshlrev_b32 v1, 4, v0
    s_waitcnt lgkmcnt(0)
    s_mov_b32 s16, s36
    s_and_b32 s17, s37, 0xffff
    s_mov_b32 s18, 256
    s_mov_b32 s19, 0x20000
    s_barrier
    buffer_load_dwordx4 v[64:67], v3, s[12:15], s33 offen offset:0
    buffer_load_dwordx4 v[68:71], v3, s[12:15], s33 offen offset:256
    buffer_load_dwordx4 v[72:75], v3, s[12:15], s33 offen offset:512
    buffer_load_dwordx4 v[76:79], v3, s[12:15], s33 offen offset:768
    buffer_load_dwordx4 v[80:83], v3, s[12:15], s33 offen offset:1024
    s_barrier
    s_barrier
    s_waitcnt vmcnt(0)
    s_mov_b64 exec, 0xffff
    s_mov_b32 s41, 262144
sequential_preLN__mha_block__glu_gated_geglu__prompt_kernel_pollz1:
    buffer_load_dword v8, v1, s[16:19], 0 offen sc1
    s_cmp_eq_u32 s41, 262144
    s_cbranch_scc0 sequential_preLN__mha_block__glu_gated_geglu__prompt_kernel_chkz1
    s_mov_b64 exec, -1
    v_lshlrev_b32 v32, 16, v64
    v_and_b32 v33, 0xffff0000, v64
    v_mov_b32 v12, v32
    v_mov_b32 v13, v33
    v_mul_f32 v14, v32, v32
    v_mul_f32 v15, v33, v33
    v_lshlrev_b32 v34, 16, v65
    v_and_b32 v35, 0xffff0000, v65
    v_add_f32 v12, v12, v34
    v_add_f32 v13, v13, v35
    v_fmac_f32 v14, v34, v34
    v_fmac_f32 v15, v35, v35
    v_lshlrev_b32 v32, 16, v66
    v_and_b32 v33, 0xffff0000, v66
    v_add_f32 v12, v12, v32
    v_add_f32 v13, v13, v33
    v_fmac_f32 v14, v32, v32
    v_fmac_f32 v15, v33, v33
    v_lshlrev_b32 v34, 16, v67
    v_and_b32 v35, 0xffff0000, v67
    v_add_f32 v12, v12, v34
    v_add_f32 v13, v13, v35
    v_fmac_f32 v14, v34, v34
    v_fmac_f32 v15, v35, v35
    v_lshlrev_b32 v32, 16, v68
    v_and_b32 v33, 0xffff0000, v68
    v_add_f32 v12, v12, v32
    v_add_f32 v13, v13, v33
    v_fmac_f32 v14, v32, v32
    v_fmac_f32 v15, v33, v33
    v_lshlrev_b32 v34, 16, v69
    v_and_b32 v35, 0xffff0000, v69
    v_add_f32 v12, v12, v34
    v_add_f32 v13, v13, v35
    v_fmac_f32 v14, v34, v34
    v_fmac_f32 v15, v35, v35
    v_lshlrev_b32 v32, 16, v70
    v_and_b32 v33, 0xffff0000, v70
    v_add_f32 v12, v12, v32
    v_add_f32 v13, v13, v33
    v_fmac_f32 v14, v32, v32
    v_fmac_f32 v15, v33, v33
    v_lshlrev_b32 v34, 16, v71
    v_and_b32 v35, 0xffff0000, v71
    v_add_f32 v12, v12, v34
    v_add_f32 v13, v13, v35
    v_fmac_f32 v14, v34, v34
    v_fmac_f32 v15, v35, v35
    v_lshlrev_b32 v32, 16, v72
    v_and_b32 v33, 0xffff0000, v72
    v_add_f32 v12, v12, v32
    v_add_f32 v13, v13, v33
    v_fmac_f32 v14, v32, v32
    v_fmac_f32 v15, v33, v33
    v_lshlrev_b32 v34, 16, v73
    v_and_b32 v35, 0xffff0000, v73
    v_add_f32 v12, v12, v34
    v_add_f32 v13, v13, v35
    v_fmac_f32 v14, v34, v34
    v_fmac_f32 v15, v35, v35
    v_lshlrev_b32 v32, 16, v74
    v_and_b32 v33, 0xffff0000, v74
    v_add_f32 v12, v12, v32
    v_add_f32 v13, v13, v33
    v_fmac_f32 v14, v32, v32
    v_fmac_f32 v15, v33, v33
    v_lshlrev_b32 v34, 16, v75
    v_and_b32 v35, 0xffff0000, v75
    v_add_f32 v12, v12, v34
    v_add_f32 v13, v13, v35
    v_fmac_f32 v14, v34, v34
    v_fmac_f32 v15, v35, v35
    s_barrier
    v_lshlrev_b32 v32, 16, v76
    v_and_b32 v33, 0xffff0000, v76
    v_add_f32 v12, v12, v32
    v_add_f32 v13, v13, v33
    v_fmac_f32 v14, v32, v32
    v_fmac_f32 v15, v33, v33
    v_lshlrev_b32 v34, 16, v77
    v_and_b32 v35, 0xffff0000, v77
    v_add_f32 v12, v12, v34
    v_add_f32 v13, v13, v35
    v_fmac_f32 v14, v34, v34
    v_fmac_f32 v15, v35, v35
    v_lshlrev_b32 v32, 16, v78
    v_and_b32 v33, 0xffff0000, v78
    v_add_f32 v12, v12, v32
    v_add_f32 v13, v13, v33
    v_fmac_f32 v14, v32, v32
    v_fmac_f32 v15, v33, v33
    v_lshlrev_b32 v34, 16, v79
    v_and_b32 v35, 0xffff0000, v79
    v_add_f32 v12, v12, v34
    v_add_f32 v13, v13, v35
    v_fmac_f32 v14, v34, v34
    v_fmac_f32 v15, v35, v35
    v_lshlrev_b32 v32, 16, v80
    v_and_b32 v33, 0xffff0000, v80
    v_add_f32 v12, v12, v32
    v_add_f32 v13, v13, v33
    v_fmac_f32 v14, v32, v32
    v_fmac_f32 v15, v33, v33
    v_lshlrev_b32 v34, 16, v81
    v_and_b32 v35, 0xffff0000, v81
    v_add_f32 v12, v12, v34
    v_add_f32 v13, v13, v35
    v_fmac_f32 v14, v34, v34
    v_fmac_f32 v15, v35, v35
    v_lshlrev_b32 v32, 16, v82
    v_and_b32 v33, 0xffff0000, v82
    v_add_f32 v12, v12, v32
    v_add_f32 v13, v13, v33
    v_fmac_f32 v14, v32, v32
    v_fmac_f32 v15, v33, v33
    v_lshlrev_b32 v34, 16, v83
    v_and_b32 v35, 0xffff0000, v83
    v_add_f32 v12, v12, v34
    v_add_f32 v13, v13, v35
    v_fmac_f32 v14, v34, v34
    v_fmac_f32 v15, v35, v35
    v_add_f32 v17, v12, v13
    v_add_f32 v14, v14, v15
    s_nop 0
    v_add_f32_dpp v17, v17, v17 row_ror:1 row_mask:0xf bank_mask:0xf
    v_add_f32_dpp v14, v14, v14 row_ror:1 row_mask:0xf bank_mask:0xf
    s_nop 0
    v_add_f32_dpp v17, v17, v17 row_ror:2 row_mask:0xf bank_mask:0xf
    v_add_f32_dpp v14, v14, v14 row_ror:2 row_mask:0xf bank_mask:0xf
    s_nop 0
    v_add_f32_dpp v17, v17, v17 row_ror:4 row_mask:0xf bank_mask:0xf
    v_add_f32_dpp v14, v14, v14 row_ror:4 row_mask:0xf bank_mask:0xf
    s_nop 0
    v_add_f32_dpp v17, v17, v17 row_ror:8 row_mask:0xf bank_mask:0xf
    v_add_f32_dpp v14, v14, v14 row_ror:8 row_mask:0xf bank_mask:0xf
    s_nop 0
    v_mul_f32 v17, 0x3acccccd, v17
    v_mul_f32 v14, 0x3acccccd, v14
    v_fma_f32 v14, -v17, v17, v14
    v_max_f32 v14, 0, v14
    v_add_f32 v14, 0x3727c5ac, v14
    v_rsq_f32 v16, v14
    v_lshlrev_b32 v9, 3, v9
    v_or_b32 v16, 1, v16
    s_lshl_b32 s33, s32, 5
    s_add_u32 s33, s33, 19464192
    s_mov_b64 exec, 0xffff
sequential_preLN__mha_block__glu_gated_geglu__prompt_kernel_chkz1:
    s_sub_u32 s41, s41, 1
    s_cbranch_scc1 sequential_preLN__mha_block__glu_gated_geglu__prompt_kernel_polledz1
    s_waitcnt vmcnt(0)
    v_cmp_ne_u32 vcc, 1, v8
    s_nop 1
    s_cbranch_vccz sequential_preLN__mha_block__glu_gated_geglu__prompt_kernel_polledz1
    s_mov_b64 exec, vcc
    s_sleep 4
    s_branch sequential_preLN__mha_block__glu_gated_geglu__prompt_kernel_pollz1
sequential_preLN__mha_block__glu_gated_geglu__prompt_kernel_polledz1:
    s_mov_b64 exec, -1
    s_mov_b32 exec_lo, 0x10001
    s_mov_b32 exec_hi, 0x10001
    buffer_store_dwordx2 v[16:17], v9, s[8:11], s33 offen sc1
    s_mov_b64 exec, -1
    s_barrier
    s_barrier
    s_barrier
    s_cmp_eq_u32 s20, 4
    s_cbranch_scc0 sequential_preLN__mha_block__glu_gated_geglu__prompt_kernel_hrest
    s_lshl_b32 s33, s21, 10
    s_add_u32 s33, s33, 19464192
    v_lshlrev_b32 v2, 3, v0
    v_add_u32 v2, 131072, v2
    s_mov_b32 s41, 262144
sequential_preLN__mha_block__glu_gated_geglu__prompt_kernel_polls:
    buffer_load_dwordx4 v[16:19], v1, s[8:11], s33 offen sc1
    s_cmp_eq_u32 s41, 262144
    s_cbranch_scc0 sequential_preLN__mha_block__glu_gated_geglu__prompt_kernel_chks
    s_barrier
    s_barrier
sequential_preLN__mha_block__glu_gated_geglu__prompt_kernel_chks:
    s_sub_u32 s41, s41, 1
    s_cbranch_scc1 sequential_preLN__mha_block__glu_gated_geglu__prompt_kernel_polleds
    s_waitcnt vmcnt(0)
    v_min_u32 v8, v16, v18
    v_min_u32 v8, 1, v8
    v_cmp_ne_u32 vcc, 1, v8
    s_nop 1
    s_cbranch_vccz sequential_preLN__mha_block__glu_gated_geglu__prompt_kernel_polleds
    s_mov_b64 exec, vcc
    s_sleep 4
    s_branch sequential_preLN__mha_block__glu_gated_geglu__prompt_kernel_polls
sequential_preLN__mha_block__glu_gated_geglu__prompt_kernel_polleds:
    s_mov_b64 exec, -1
    v_mul_f32 v20, v17, v16
    v_mul_f32 v21, v19, v18
    v_mov_b32 v17, v18
    ds_write_b64 v2, v[16:17]
    ds_write_b64 v2, v[20:21] offset:512
    s_waitcnt lgkmcnt(0)
    s_barrier
    s_barrier
    s_branch sequential_preLN__mha_block__glu_gated_geglu__prompt_kernel_hdone
sequential_preLN__mha_block__glu_gated_geglu__prompt_kernel_hidle:
    s_cmp_eq_u32 s20, 6
    s_cbranch_scc0 sequential_preLN__mha_block__glu_gated_geglu__prompt_kernel_nopf
    s_getpc_b64 s[42:43]
sequential_preLN__mha_block__glu_gated_geglu__prompt_kernel_pc:
    s_sub_u32 s42, s42, sequential_preLN__mha_block__glu_gated_geglu__prompt_kernel_pc - sequential_preLN__mha_block__glu_gated_geglu__prompt_kernel
    s_subb_u32 s43, s43, 0
    s_lshr_b32 s44, s2, 3
    s_min_u32 s44, s44, (sequential_preLN__mha_block__glu_gated_geglu__prompt_kernel_codeend - sequential_preLN__mha_block__glu_gated_geglu__prompt_kernel) / 1024 - 1
    s_lshl_b32 s44, s44, 10
    s_add_u32 s42, s42, s44
    s_addc_u32 s43, s43, 0
    v_lshlrev_b32 v2, 4, v0
    v_mov_b32 v3, s43
    v_add_co_u32 v2, vcc, s42, v2
    s_nop 1
    v_addc_co_u32 v3, vcc, 0, v3, vcc
    global_load_dwordx4 v[60:63], v[2:3], off
sequential_preLN__mha_block__glu_gated_geglu__prompt_kernel_nopf:
    s_barrier
    s_barrier
    s_barrier
    s_barrier
    s_barrier
    s_barrier
    s_barrier
sequential_preLN__mha_block__glu_gated_geglu__prompt_kernel_hrest:
    s_barrier
    s_barrier
    s_barrier
    s_barrier
sequential_preLN__mha_block__glu_gated_geglu__prompt_kernel_hdone:
    s_waitcnt vmcnt(0) lgkmcnt(0)
    s_barrier
    s_branch sequential_preLN__mha_block__glu_gated_geglu__prompt_kernel_p2_entry
sequential_preLN__mha_block__glu_gated_geglu__prompt_kernel_clear:
    s_cmp_eq_u32 s20, 0
    s_cbranch_scc0 sequential_preLN__mha_block__glu_gated_geglu__prompt_kernel_noclear
    s_load_dwordx2 s[36:37], s[0:1], 64
    v_mov_b32 v4, 0
    v_mov_b32 v5, 0
    v_mov_b32 v6, 0
    v_mov_b32 v7, 0
    v_lshlrev_b32 v2, 4, v0
    s_lshl_b32 s39, s21, 11
    s_add_u32 s39, s39, 19484672
    s_lshl_b32 s33, s21, 10
    s_add_u32 s33, s33, 19464192
    buffer_store_dwordx4 v[4:7], v2, s[8:11], s33 offen sc1
    buffer_store_dwordx4 v[4:7], v2, s[8:11], s39 offen sc1
    buffer_store_dwordx4 v[4:7], v2, s[8:11], s39 offen offset:1024 sc1
    s_add_u32 s39, s39, 32768
    buffer_store_dwordx4 v[4:7], v2, s[8:11], s39 offen sc1
    buffer_store_dwordx4 v[4:7], v2, s[8:11], s39 offen offset:1024 sc1
    s_add_u32 s39, s39, 32768
    buffer_store_dwordx4 v[4:7], v2, s[8:11], s39 offen sc1
    buffer_store_dwordx4 v[4:7], v2, s[8:11], s39 offen offset:1024 sc1
    s_add_u32 s39, s39, 32768
    buffer_store_dwordx4 v[4:7], v2, s[8:11], s39 offen sc1
    buffer_store_dwordx4 v[4:7], v2, s[8:11], s39 offen offset:1024 sc1
    s_add_u32 s39, s39, 32768
    buffer_store_dwordx4 v[4:7], v2, s[8:11], s39 offen sc1
    buffer_store_dwordx4 v[4:7], v2, s[8:11], s39 offen offset:1024 sc1
    s_add_u32 s39, s39, 32768
    v_mov_b32 v8, 1
    s_lshl_b32 s33, s21, 4
    s_waitcnt lgkmcnt(0)
    s_mov_b32 s16, s36
    s_and_b32 s17, s37, 0xffff
    s_mov_b32 s18, 256
    s_mov_b32 s19, 0x20000
    s_mov_b64 exec, 1
    s_waitcnt vmcnt(0)
    buffer_store_dword v8, v4, s[16:19], s33 offen sc1
    s_mov_b64 exec, -1
sequential_preLN__mha_block__glu_gated_geglu__prompt_kernel_noclear:
    s_barrier
    s_barrier
    s_barrier
    s_barrier
    s_barrier
    s_barrier
    s_barrier
    s_barrier
    s_barrier
    s_barrier
    s_barrier
    s_barrier
    s_branch sequential_preLN__mha_block__glu_gated_geglu__prompt_kernel_p2_entry
sequential_preLN__mha_block__glu_gated_geglu__prompt_kernel_bar:
    s_barrier
    s_branch sequential_preLN__mha_block__glu_gated_geglu__prompt_kernel_barback
sequential_preLN__mha_block__glu_gated_geglu__prompt_kernel_loader:
    s_lshl_b32 s56, s21, 4
    s_add_u32 s56, s56, s22
    s_load_dwordx4 s[64:67], s[0:1], 32
    s_load_dwordx2 s[68:69], s[0:1], 0
    s_and_b32 s6, s2, 7
    s_lshr_b32 s73, s2, 5
    s_lshl_b32 s72, s6, 2
    s_bfe_u32 s3, s2, 0x20003
    s_add_u32 s72, s72, s3
    s_and_b32 s74, s2, 6
    s_bfe_u32 s3, s2, 0x10003
    s_add_u32 s74, s74, s3
    s_and_b32 s75, s2, 1
    s_lshl_b32 s75, s75, 4
    s_lshr_b32 s3, s2, 4
    s_add_u32 s75, s75, s3
    s_and_b32 s21, s2, 7
    s_lshl_b32 s21, s21, 2
    s_bfe_u32 s27, s2, 0x20003
    s_add_u32 s21, s21, s27
    s_mul_i32 s25, s21, 163840
    s_add_u32 s25, s25, 2621440
    s_mov_b32 s63, s25
    s_mov_b32 s54, 6554
    s_mov_b32 s55, 10923
    v_add_u32 v2, 0, v0
    v_mul_u32_u24 v3, s55, v2
    v_lshrrev_b32 v3, 16, v3
    v_mul_u32_u24 v6, 6, v3
    v_sub_u32 v6, v2, v6
    v_bfe_u32 v8, v3, 2, 1
    v_bfe_u32 v9, v3, 3, 1
    v_and_b32 v7, 0x13, v3
    v_lshl_or_b32 v7, v8, 3, v7
    v_lshl_or_b32 v7, v9, 2, v7
    v_mul_u32_u24 v10, 3072, v7
    v_lshl_add_u32 v17, v6, 4, v10
    v_add_u32 v2, 64, v0
    v_mul_u32_u24 v3, s55, v2
    v_lshrrev_b32 v3, 16, v3
    v_mul_u32_u24 v6, 6, v3
    v_sub_u32 v6, v2, v6
    v_bfe_u32 v8, v3, 2, 1
    v_bfe_u32 v9, v3, 3, 1
    v_and_b32 v7, 0x13, v3
    v_lshl_or_b32 v7, v8, 3, v7
    v_lshl_or_b32 v7, v9, 2, v7
    v_mul_u32_u24 v10, 3072, v7
    v_lshl_add_u32 v18, v6, 4, v10
    v_add_u32 v2, 128, v0
    v_mul_u32_u24 v3, s55, v2
    v_lshrrev_b32 v3, 16, v3
    v_mul_u32_u24 v6, 6, v3
    v_sub_u32 v6, v2, v6
    v_bfe_u32 v8, v3, 2, 1
    v_bfe_u32 v9, v3, 3, 1
    v_and_b32 v7, 0x13, v3
    v_lshl_or_b32 v7, v8, 3, v7
    v_lshl_or_b32 v7, v9, 2, v7
    v_mul_u32_u24 v10, 3072, v7
    v_lshl_add_u32 v19, v6, 4, v10
    s_mul_i32 s47, s20, 5120
    s_add_u32 s47, s47, 143360
    v_add_u32 v21, s47, v1
    v_bfe_u32 v10, v0, 2, 2
    v_bfe_u32 v11, v0, 4, 1
    v_lshl_add_u32 v10, v11, 2, v10
    v_lshrrev_b32 v11, 5, v0
    v_lshl_add_u32 v10, v11, 4, v10
    v_mul_u32_u24 v10, 96, v10
    v_and_b32 v11, 3, v0
    v_lshl_add_u32 v10, v11, 3, v10
    v_add_u32 v20, s47, v10
    v_add_u32 v2, 0, v0
    v_mul_u32_u24 v3, s54, v2
    v_lshrrev_b32 v3, 16, v3
    v_mul_u32_u24 v3, 1120, v3
    v_lshl_add_u32 v12, v2, 4, v3
    v_add_u32 v2, 64, v0
    v_mul_u32_u24 v3, s54, v2
    v_lshrrev_b32 v3, 16, v3
    v_mul_u32_u24 v3, 1120, v3
    v_lshl_add_u32 v13, v2, 4, v3
    v_add_u32 v2, 128, v0
    v_mul_u32_u24 v3, s54, v2
    v_lshrrev_b32 v3, 16, v3
    v_mul_u32_u24 v3, 1120, v3
    v_lshl_add_u32 v14, v2, 4, v3
    v_add_u32 v2, 192, v0
    v_mul_u32_u24 v3, s54, v2
    v_lshrrev_b32 v3, 16, v3
    v_mul_u32_u24 v3, 1120, v3
    v_lshl_add_u32 v15, v2, 4, v3
    v_add_u32 v2, 256, v0
    v_mul_u32_u24 v3, s54, v2
    v_lshrrev_b32 v3, 16, v3
    v_mul_u32_u24 v3, 1120, v3
    v_lshl_add_u32 v16, v2, 4, v3
    v_and_b32 v5, 31, v0
    v_mul_u32_u24 v4, 128, v5
    v_lshlrev_b32 v5, 7, v5
    s_lshr_b32 s46, s21, 1
    s_mul_i32 s46, s46, 5
    s_and_b32 s47, s21, 1
    s_lshl_b32 s47, s47, 1
    s_add_u32 s46, s46, s47
    s_add_u32 s47, s46, 2
    s_lshr_b32 s46, s46, 4
    s_lshr_b32 s47, s47, 4
    s_mul_i32 s48, s21, 20
    s_add_u32 s49, s48, 19
    s_lshr_b32 s48, s48, 7
    s_lshr_b32 s49, s49, 7
    s_add_u32 s48, s48, 5
    s_add_u32 s49, s49, 5
    s_lshr_b32 s50, s2, 5
    s_lshl_b32 s50, s50, 1
    v_and_b32 v8, 16, v0
    v_cmp_ne_u32 vcc, 0, v8
    v_mov_b32 v6, s46
    v_mov_b32 v7, s47
    v_mov_b32 v8, s48
    v_mov_b32 v9, s49
    v_cndmask_b32 v7, v6, v7, vcc
    v_cndmask_b32 v8, v8, v9, vcc
    v_cmp_le_u32 vcc, 32, v0
    v_and_b32 v9, 15, v0
    v_and_b32 v10, 1, v0
    v_cndmask_b32 v6, v7, v8, vcc
    v_lshl_add_u32 v6, v9, 4, v6
    v_add_lshl_u32 v6, v6, 5, 7
    v_add_u32 v10, s50, v10
    v_lshl_add_u32 v7, v10, 4, v7
    v_lshlrev_b32 v7, 7, v7
    v_lshlrev_b32 v22, 7, v0
    v_mov_b32 v3, v7
    v_mov_b32 v7, 0
    v_mov_b32 v23, 1
    s_mov_b32 s57, s2
    s_lshl_b32 s58, s72, 3
    s_add_u32 s58, s58, s73
    s_lshl_b32 s59, s74, 5
    s_add_u32 s59, s59, s75
    s_lshl_b32 s56, s56, 7
    s_add_u32 s56, s56, 19484672
    s_cmp_eq_u32 s20, 1
    s_cselect_b32 s56, s56, 1073741824
    s_lshl_b32 s57, s57, 7
    s_add_u32 s57, s57, 19517440
    s_cmp_eq_u32 s20, 1
    s_cselect_b32 s57, s57, 1073741824
    s_lshl_b32 s58, s58, 7
    s_add_u32 s58, s58, 19550208
    s_cmp_eq_u32 s20, 1
    s_cselect_b32 s58, s58, 1073741824
    s_lshl_b32 s59, s59, 7
    s_add_u32 s59, s59, 19582976
    s_cmp_eq_u32 s20, 1
    s_cselect_b32 s59, s59, 1073741824
    s_waitcnt lgkmcnt(0)
    s_barrier
    s_mov_b64 exec, 1
    buffer_store_dword v23, v7, s[8:11], s56 offen sc1
    s_mov_b64 exec, -1
    s_mov_b32 s12, s64
    s_and_b32 s13, s65, 0xffff
    s_mov_b32 s14, 1966080
    s_mov_b32 s15, 0x20000
    s_mov_b32 s16, s66
    s_and_b32 s17, s67, 0xffff
    s_mov_b32 s18, 1966080
    s_mov_b32 s19, 0x20000
    s_mul_i32 s47, s75, 96
    s_mul_i32 s33, s20, 491520
    s_add_u32 s33, s33, s47
    s_add_u32 s33, s33, 393216
    buffer_load_dwordx4 v[128:131], v17, s[12:15], s33 offen
    buffer_load_dwordx4 v[132:135], v18, s[12:15], s33 offen
    buffer_load_dwordx4 v[136:139], v19, s[12:15], s33 offen
    buffer_load_dwordx4 v[140:143], v17, s[16:19], s33 offen
    buffer_load_dwordx4 v[144:147], v18, s[16:19], s33 offen
    buffer_load_dwordx4 v[148:151], v19, s[16:19], s33 offen
    s_cmp_eq_u32 s20, 0
    s_cbranch_scc0 sequential_preLN__mha_block__glu_gated_geglu__prompt_kernel_l_b1
    s_mov_b32 s40, 19484672
    s_mov_b32 s41, 262144
sequential_preLN__mha_block__glu_gated_geglu__prompt_kernel_poll0:
    buffer_load_dword v8, v6, s[8:11], s40 offen sc1
    buffer_load_dword v9, v3, s[8:11], s40 offen sc1
    s_sub_u32 s41, s41, 1
    s_cbranch_scc1 sequential_preLN__mha_block__glu_gated_geglu__prompt_kernel_polled0
    s_waitcnt vmcnt(0)
    v_and_b32 v8, v8, v9
    v_cmp_ne_u32 vcc, 1, v8
    s_nop 1
    s_cbranch_vccz sequential_preLN__mha_block__glu_gated_geglu__prompt_kernel_polled0
    s_mov_b64 exec, vcc
    s_sleep 4
    s_branch sequential_preLN__mha_block__glu_gated_geglu__prompt_kernel_poll0
sequential_preLN__mha_block__glu_gated_geglu__prompt_kernel_polled0:
    s_mov_b64 exec, -1
sequential_preLN__mha_block__glu_gated_geglu__prompt_kernel_l_b1:
    s_barrier
    s_lshl_b32 s30, s20, 10
    s_add_u32 s29, s25, s30
    s_mov_b32 s22, 5
sequential_preLN__mha_block__glu_gated_geglu__prompt_kernel_ld0:
    s_mov_b32 m0, s30
    s_add_u32 s30, s30, 4096
    buffer_load_dwordx4 v1, s[8:11], s29 offen sc1 lds
    s_add_u32 s29, s29, 4096
    s_sub_u32 s22, s22, 1
    s_cmp_lg_u32 s22, 0
    s_cbranch_scc1 sequential_preLN__mha_block__glu_gated_geglu__prompt_kernel_ld0
    s_mov_b32 m0, s30
    s_add_u32 s30, s30, 4096
    buffer_load_dwordx4 v1, s[8:11], s29 offen sc1 lds
    s_add_u32 s29, s29, 4096
    s_mov_b32 m0, s30
    s_add_u32 s30, s30, 4096
    buffer_load_dwordx4 v1, s[8:11], s29 offen sc1 lds
    s_add_u32 s29, s29, 4096
    s_mov_b32 m0, s30
    s_add_u32 s30, s30, 4096
    buffer_load_dwordx4 v1, s[8:11], s29 offen sc1 lds
    s_add_u32 s29, s29, 4096
    s_mov_b32 m0, s30
    s_add_u32 s30, s30, 4096
    buffer_load_dwordx4 v1, s[8:11], s29 offen sc1 lds
    s_add_u32 s29, s29, 4096
    s_waitcnt vmcnt(4)
    s_barrier
    s_mov_b32 s22, 26
sequential_preLN__mha_block__glu_gated_geglu__prompt_kernel_ld1:
    s_mov_b32 m0, s30
    s_add_u32 s30, s30, 4096
    buffer_load_dwordx4 v1, s[8:11], s29 offen sc1 lds
    s_add_u32 s29, s29, 4096
    s_waitcnt vmcnt(40)
    s_sub_u32 s22, s22, 1
    s_cmp_lg_u32 s22, 0
    s_cbranch_scc1 sequential_preLN__mha_block__glu_gated_geglu__prompt_kernel_ld1
    buffer_store_dwordx4 v[64:67], v1, s[8:11], s61 offen offset:0 sc1
    buffer_store_dwordx4 v[68:71], v1, s[8:11], s61 offen offset:1024 sc1
    buffer_store_dwordx4 v[72:75], v1, s[8:11], s61 offen offset:2048 sc1
    buffer_store_dwordx4 v[76:79], v1, s[8:11], s61 offen offset:3072 sc1
    s_add_u32 s61, s61, 4096
    buffer_store_dwordx4 v[80:83], v1, s[8:11], s61 offen sc1
    s_mov_b64 exec, 1
    buffer_store_short v41, v43, s[8:11], s62 offen sc1
    buffer_store_short v42, v43, s[8:11], s62 offen offset:16 sc1
    s_mov_b64 exec, -1
    s_mul_i32 s34, s73, 348160
    s_add_u32 s34, s34, 19648512
    s_mul_i32 s31, s73, 160
    s_and_b32 s48, s72, 3
    s_lshl_b32 s48, s48, 2
    s_add_u32 s48, s48, s20
    s_mov_b32 s24, s68
    s_and_b32 s25, s69, 0xffff
    s_mov_b32 s26, 2621440
    s_mov_b32 s27, 0x20000
    s_lshr_b32 s32, s2, 3
    s_lshl_b32 s32, s32, 2
    s_add_u32 s32, s32, s20
    s_mul_i32 s33, s32, 2560
    s_mul_i32 s35, s6, 327680
    s_add_u32 s33, s33, s35
    buffer_load_dwordx4 v[24:27], v1, s[24:27], s33 offen offset:0
    buffer_load_dwordx4 v[24:27], v1, s[24:27], s33 offen offset:1024
    buffer_load_dwordx4 v[24:27], v1, s[24:27], s33 offen offset:2048
    s_waitcnt vmcnt(10)
    s_barrier
    s_lshl_b32 s40, s2, 7
    s_lshl_b32 s41, s20, 2
    s_add_u32 s40, s40, s41
    s_add_u32 s40, s40, 19615744
    v_mov_b32 v10, 1
    v_mov_b32 v11, 0
    s_waitcnt vmcnt(0)
    s_mov_b64 exec, 1
    buffer_store_dword v10, v11, s[8:11], s40 offen sc1
    s_mov_b64 exec, -1
    s_mul_i32 s47, s75, 96
    s_mul_i32 s33, s20, 491520
    s_add_u32 s33, s33, s47
    s_add_u32 s33, s33, 0
    buffer_load_dwordx4 v[32:35], v17, s[12:15], s33 offen
    buffer_load_dwordx4 v[36:39], v18, s[12:15], s33 offen
    buffer_load_dwordx4 v[40:43], v19, s[12:15], s33 offen
    buffer_load_dwordx4 v[44:47], v17, s[16:19], s33 offen
    buffer_load_dwordx4 v[48:51], v18, s[16:19], s33 offen
    buffer_load_dwordx4 v[52:55], v19, s[16:19], s33 offen
    s_mul_i32 s47, s75, 96
    s_mul_i32 s33, s20, 491520
    s_add_u32 s33, s33, s47
    s_add_u32 s33, s33, 98304
    buffer_load_dwordx4 v[56:59], v17, s[12:15], s33 offen
    buffer_load_dwordx4 v[60:63], v18, s[12:15], s33 offen
    buffer_load_dwordx4 v[64:67], v19, s[12:15], s33 offen
    buffer_load_dwordx4 v[68:71], v17, s[16:19], s33 offen
    buffer_load_dwordx4 v[72:75], v18, s[16:19], s33 offen
    buffer_load_dwordx4 v[76:79], v19, s[16:19], s33 offen
    s_mul_i32 s47, s75, 96
    s_mul_i32 s33, s20, 491520
    s_add_u32 s33, s33, s47
    s_add_u32 s33, s33, 196608
    buffer_load_dwordx4 v[80:83], v17, s[12:15], s33 offen
    buffer_load_dwordx4 v[84:87], v18, s[12:15], s33 offen
    buffer_load_dwordx4 v[88:91], v19, s[12:15], s33 offen
    buffer_load_dwordx4 v[92:95], v17, s[16:19], s33 offen
    buffer_load_dwordx4 v[96:99], v18, s[16:19], s33 offen
    buffer_load_dwordx4 v[100:103], v19, s[16:19], s33 offen
    s_mul_i32 s47, s75, 96
    s_mul_i32 s33, s20, 491520
    s_add_u32 s33, s33, s47
    s_add_u32 s33, s33, 294912
    buffer_load_dwordx4 v[104:107], v17, s[12:15], s33 offen
    buffer_load_dwordx4 v[108:111], v18, s[12:15], s33 offen
    buffer_load_dwordx4 v[112:115], v19, s[12:15], s33 offen
    buffer_load_dwordx4 v[116:119], v17, s[16:19], s33 offen
    buffer_load_dwordx4 v[120:123], v18, s[16:19], s33 offen
    buffer_load_dwordx4 v[124:127], v19, s[16:19], s33 offen
    s_lshl_b32 s40, s73, 12
    s_add_u32 s40, s40, 19615744
    s_mov_b32 s41, 262144
sequential_preLN__mha_block__glu_gated_geglu__prompt_kernel_pollj:
    buffer_load_dwordx4 v[8:11], v5, s[8:11], s40 offen sc1
    s_sub_u32 s41, s41, 1
    s_cbranch_scc1 sequential_preLN__mha_block__glu_gated_geglu__prompt_kernel_polledj
    s_waitcnt vmcnt(0)
    v_and_b32 v8, v8, v9
    v_and_b32 v10, v10, v11
    v_and_b32 v8, v8, v10
    v_cmp_ne_u32 vcc, 1, v8
    s_nop 1
    s_cbranch_vccz sequential_preLN__mha_block__glu_gated_geglu__prompt_kernel_polledj
    s_mov_b64 exec, vcc
    s_sleep 4
    s_branch sequential_preLN__mha_block__glu_gated_geglu__prompt_kernel_pollj
sequential_preLN__mha_block__glu_gated_geglu__prompt_kernel_polledj:
    s_mov_b64 exec, -1
    s_cmp_eq_u32 s20, 0
    s_cbranch_scc1 sequential_preLN__mha_block__glu_gated_geglu__prompt_kernel_l_notbl
    s_sub_u32 s33, s20, 1
    s_lshl_b32 s33, s33, 1
    s_lshl_b32 s40, s33, 12
    s_add_u32 s40, s40, 19615744
    s_mov_b32 s41, 262144
sequential_preLN__mha_block__glu_gated_geglu__prompt_kernel_pollt:
    buffer_load_dwordx4 v[8:11], v22, s[8:11], s40 offen sc1
    s_sub_u32 s41, s41, 1
    s_cbranch_scc1 sequential_preLN__mha_block__glu_gated_geglu__prompt_kernel_polledt
    s_waitcnt vmcnt(0)
    v_and_b32 v8, v8, v9
    v_and_b32 v10, v10, v11
    v_and_b32 v8, v8, v10
    v_cmp_ne_u32 vcc, 1, v8
    s_nop 1
    s_cbranch_vccz sequential_preLN__mha_block__glu_gated_geglu__prompt_kernel_polledt
    s_mov_b64 exec, vcc
    s_sleep 4
    s_branch sequential_preLN__mha_block__glu_gated_geglu__prompt_kernel_pollt
sequential_preLN__mha_block__glu_gated_geglu__prompt_kernel_polledt:
    s_mov_b64 exec, -1
sequential_preLN__mha_block__glu_gated_geglu__prompt_kernel_l_notbl:
    s_mul_i32 s33, s48, 6400
    s_add_u32 s33, s33, s34
    buffer_load_dwordx4 v[24:27], v1, s[8:11], s33 offen offset:0 sc1
    buffer_load_dwordx4 v[24:27], v1, s[8:11], s33 offen offset:1024 sc1
    buffer_load_dwordx4 v[24:27], v1, s[8:11], s33 offen offset:2048 sc1
    buffer_load_dwordx4 v[24:27], v1, s[8:11], s33 offen offset:3072 sc1
    s_add_u32 s33, s33, 4096
    buffer_load_dwordx4 v[24:27], v1, s[8:11], s33 offen offset:0 sc1
    buffer_load_dwordx4 v[24:27], v1, s[8:11], s33 offen offset:1024 sc1
    buffer_load_dwordx4 v[24:27], v1, s[8:11], s33 offen offset:2048 sc1
    ds_write_b128 v21, v[32:35] offset:0
    ds_write_b128 v21, v[36:39] offset:1024
    ds_write_b128 v21, v[40:43] offset:2048
    s_waitcnt lgkmcnt(0)
    ds_read_b64_tr_b16 v[32:33], v20 offset:0
    ds_read_b64_tr_b16 v[34:35], v20 offset:768
    ds_read_b64_tr_b16 v[36:37], v20 offset:32
    ds_read_b64_tr_b16 v[38:39], v20 offset:800
    ds_read_b64_tr_b16 v[40:41], v20 offset:64
    ds_read_b64_tr_b16 v[42:43], v20 offset:832
    s_waitcnt lgkmcnt(0)
    ds_write_b128 v21, v[44:47] offset:0
    ds_write_b128 v21, v[48:51] offset:1024
    ds_write_b128 v21, v[52:55] offset:2048
    s_waitcnt lgkmcnt(0)
    ds_read_b64_tr_b16 v[44:45], v20 offset:0
    ds_read_b64_tr_b16 v[46:47], v20 offset:768
    ds_read_b64_tr_b16 v[48:49], v20 offset:32
    ds_read_b64_tr_b16 v[50:51], v20 offset:800
    ds_read_b64_tr_b16 v[52:53], v20 offset:64
    ds_read_b64_tr_b16 v[54:55], v20 offset:832
    s_waitcnt lgkmcnt(0)
    ds_write_b128 v21, v[56:59] offset:0
    ds_write_b128 v21, v[60:63] offset:1024
    ds_write_b128 v21, v[64:67] offset:2048
    s_waitcnt lgkmcnt(0)
    ds_read_b64_tr_b16 v[56:57], v20 offset:0
    ds_read_b64_tr_b16 v[58:59], v20 offset:768
    ds_read_b64_tr_b16 v[60:61], v20 offset:32
    ds_read_b64_tr_b16 v[62:63], v20 offset:800
    ds_read_b64_tr_b16 v[64:65], v20 offset:64
    ds_read_b64_tr_b16 v[66:67], v20 offset:832
    s_waitcnt lgkmcnt(0)
    ds_write_b128 v21, v[68:71] offset:0
    ds_write_b128 v21, v[72:75] offset:1024
    ds_write_b128 v21, v[76:79] offset:2048
    s_waitcnt lgkmcnt(0)
    ds_read_b64_tr_b16 v[68:69], v20 offset:0
    ds_read_b64_tr_b16 v[70:71], v20 offset:768
    ds_read_b64_tr_b16 v[72:73], v20 offset:32
    ds_read_b64_tr_b16 v[74:75], v20 offset:800
    ds_read_b64_tr_b16 v[76:77], v20 offset:64
    ds_read_b64_tr_b16 v[78:79], v20 offset:832
    s_waitcnt lgkmcnt(0)
    ds_write_b128 v21, v[80:83] offset:0
    ds_write_b128 v21, v[84:87] offset:1024
    ds_write_b128 v21, v[88:91] offset:2048
    s_waitcnt lgkmcnt(0)
    ds_read_b64_tr_b16 v[80:81], v20 offset:0
    ds_read_b64_tr_b16 v[82:83], v20 offset:768
    ds_read_b64_tr_b16 v[84:85], v20 offset:32
    ds_read_b64_tr_b16 v[86:87], v20 offset:800
    ds_read_b64_tr_b16 v[88:89], v20 offset:64
    ds_read_b64_tr_b16 v[90:91], v20 offset:832
    s_waitcnt lgkmcnt(0)
    ds_write_b128 v21, v[92:95] offset:0
    ds_write_b128 v21, v[96:99] offset:1024
    ds_write_b128 v21, v[100:103] offset:2048
    s_waitcnt lgkmcnt(0)
    ds_read_b64_tr_b16 v[92:93], v20 offset:0
    ds_read_b64_tr_b16 v[94:95], v20 offset:768
    ds_read_b64_tr_b16 v[96:97], v20 offset:32
    ds_read_b64_tr_b16 v[98:99], v20 offset:800
    ds_read_b64_tr_b16 v[100:101], v20 offset:64
    ds_read_b64_tr_b16 v[102:103], v20 offset:832
    s_waitcnt lgkmcnt(0)
    ds_write_b128 v21, v[104:107] offset:0
    ds_write_b128 v21, v[108:111] offset:1024
    ds_write_b128 v21, v[112:115] offset:2048
    s_waitcnt lgkmcnt(0)
    ds_read_b64_tr_b16 v[104:105], v20 offset:0
    ds_read_b64_tr_b16 v[106:107], v20 offset:768
    ds_read_b64_tr_b16 v[108:109], v20 offset:32
    ds_read_b64_tr_b16 v[110:111], v20 offset:800
    ds_read_b64_tr_b16 v[112:113], v20 offset:64
    ds_read_b64_tr_b16 v[114:115], v20 offset:832
    s_waitcnt lgkmcnt(0)
    ds_write_b128 v21, v[116:119] offset:0
    ds_write_b128 v21, v[120:123] offset:1024
    ds_write_b128 v21, v[124:127] offset:2048
    s_waitcnt lgkmcnt(0)
    ds_read_b64_tr_b16 v[116:117], v20 offset:0
    ds_read_b64_tr_b16 v[118:119], v20 offset:768
    ds_read_b64_tr_b16 v[120:121], v20 offset:32
    ds_read_b64_tr_b16 v[122:123], v20 offset:800
    ds_read_b64_tr_b16 v[124:125], v20 offset:64
    ds_read_b64_tr_b16 v[126:127], v20 offset:832
    s_waitcnt lgkmcnt(0)
    ds_write_b128 v21, v[128:131] offset:0
    ds_write_b128 v21, v[132:135] offset:1024
    ds_write_b128 v21, v[136:139] offset:2048
    s_waitcnt lgkmcnt(0)
    ds_read_b64_tr_b16 v[128:129], v20 offset:0
    ds_read_b64_tr_b16 v[130:131], v20 offset:768
    ds_read_b64_tr_b16 v[132:133], v20 offset:32
    ds_read_b64_tr_b16 v[134:135], v20 offset:800
    ds_read_b64_tr_b16 v[136:137], v20 offset:64
    ds_read_b64_tr_b16 v[138:139], v20 offset:832
    s_waitcnt lgkmcnt(0)
    ds_write_b128 v21, v[140:143] offset:0
    ds_write_b128 v21, v[144:147] offset:1024
    ds_write_b128 v21, v[148:151] offset:2048
    s_waitcnt lgkmcnt(0)
    ds_read_b64_tr_b16 v[140:141], v20 offset:0
    ds_read_b64_tr_b16 v[142:143], v20 offset:768
    ds_read_b64_tr_b16 v[144:145], v20 offset:32
    ds_read_b64_tr_b16 v[146:147], v20 offset:800
    ds_read_b64_tr_b16 v[148:149], v20 offset:64
    ds_read_b64_tr_b16 v[150:151], v20 offset:832
    s_waitcnt lgkmcnt(0)
    s_mul_i32 s33, s20, 5120
    s_add_u32 s33, s33, 143360
    s_add_u32 s32, s33, s63
    s_mov_b32 s35, 5
sequential_preLN__mha_block__glu_gated_geglu__prompt_kernel_l_kv7:
    s_mov_b32 m0, s33
    s_add_u32 s33, s33, 1024
    buffer_load_dwordx4 v1, s[8:11], s32 offen sc1 lds
    s_add_u32 s32, s32, 1024
    s_sub_u32 s35, s35, 1
    s_cmp_lg_u32 s35, 0
    s_cbranch_scc1 sequential_preLN__mha_block__glu_gated_geglu__prompt_kernel_l_kv7
    s_mul_i32 s33, s48, 15360
    s_add_u32 s33, s33, s34
    s_add_u32 s33, s33, 102400
    buffer_load_dwordx4 v[24:27], v1, s[8:11], s33 offen offset:0 sc1
    buffer_load_dwordx4 v[24:27], v1, s[8:11], s33 offen offset:1024 sc1
    buffer_load_dwordx4 v[24:27], v1, s[8:11], s33 offen offset:2048 sc1
    buffer_load_dwordx4 v[24:27], v1, s[8:11], s33 offen offset:3072 sc1
    s_add_u32 s33, s33, 4096
    buffer_load_dwordx4 v[24:27], v1, s[8:11], s33 offen offset:0 sc1
    buffer_load_dwordx4 v[24:27], v1, s[8:11], s33 offen offset:1024 sc1
    buffer_load_dwordx4 v[24:27], v1, s[8:11], s33 offen offset:2048 sc1
    buffer_load_dwordx4 v[24:27], v1, s[8:11], s33 offen offset:3072 sc1
    s_add_u32 s33, s33, 4096
    buffer_load_dwordx4 v[24:27], v1, s[8:11], s33 offen offset:0 sc1
    buffer_load_dwordx4 v[24:27], v1, s[8:11], s33 offen offset:1024 sc1
    buffer_load_dwordx4 v[24:27], v1, s[8:11], s33 offen offset:2048 sc1
    buffer_load_dwordx4 v[24:27], v1, s[8:11], s33 offen offset:3072 sc1
    s_add_u32 s33, s33, 4096
    buffer_load_dwordx4 v[24:27], v1, s[8:11], s33 offen offset:0 sc1
    buffer_load_dwordx4 v[24:27], v1, s[8:11], s33 offen offset:1024 sc1
    buffer_load_dwordx4 v[24:27], v1, s[8:11], s33 offen offset:2048 sc1
    s_mul_i32 s33, s20, 25600
    s_add_u32 s32, s33, s34
    s_waitcnt vmcnt(15)
    s_barrier
    s_mov_b32 s35, 25
sequential_preLN__mha_block__glu_gated_geglu__prompt_kernel_l_w3:
    s_mov_b32 m0, s33
    s_add_u32 s33, s33, 1024
    buffer_load_dwordx4 v1, s[8:11], s32 offen sc1 lds
    s_add_u32 s32, s32, 1024
    s_sub_u32 s35, s35, 1
    s_cmp_lg_u32 s35, 0
    s_cbranch_scc1 sequential_preLN__mha_block__glu_gated_geglu__prompt_kernel_l_w3
    s_cmp_ge_u32 s20, 2
    s_cbranch_scc1 sequential_preLN__mha_block__glu_gated_geglu__prompt_kernel_l_x
    s_cmp_eq_u32 s20, 0
    s_cbranch_scc1 sequential_preLN__mha_block__glu_gated_geglu__prompt_kernel_l_a2
    s_mov_b32 s32, 19480576
    s_mov_b32 s33, 102400
    s_mov_b32 s35, 3
sequential_preLN__mha_block__glu_gated_geglu__prompt_kernel_l_tbl:
    s_mov_b32 m0, s33
    s_add_u32 s33, s33, 1024
    buffer_load_dwordx4 v1, s[8:11], s32 offen sc1 lds
    s_add_u32 s32, s32, 1024
    s_sub_u32 s35, s35, 1
    s_cmp_lg_u32 s35, 0
    s_cbranch_scc1 sequential_preLN__mha_block__glu_gated_geglu__prompt_kernel_l_tbl
    s_branch sequential_preLN__mha_block__glu_gated_geglu__prompt_kernel_l_a2
sequential_preLN__mha_block__glu_gated_geglu__prompt_kernel_l_x:
    s_lshl_b32 s32, s72, 1
    s_add_u32 s32, s32, s20
    s_sub_u32 s32, s32, 2
    s_mul_i32 s32, s32, 40960
    s_add_u32 s32, s32, s31
    s_mul_i32 s33, s20, 5120
    s_add_u32 s33, s33, 95232
    s_mov_b32 m0, s33
    s_add_u32 s33, s33, 1024
    buffer_load_dwordx4 v12, s[24:27], s32 offen lds
    s_mov_b32 m0, s33
    s_add_u32 s33, s33, 1024
    buffer_load_dwordx4 v13, s[24:27], s32 offen lds
    s_mov_b32 m0, s33
    s_add_u32 s33, s33, 1024
    buffer_load_dwordx4 v14, s[24:27], s32 offen lds
    s_mov_b32 m0, s33
    s_add_u32 s33, s33, 1024
    buffer_load_dwordx4 v15, s[24:27], s32 offen lds
    s_mov_b32 m0, s33
    s_add_u32 s33, s33, 1024
    buffer_load_dwordx4 v16, s[24:27], s32 offen lds
sequential_preLN__mha_block__glu_gated_geglu__prompt_kernel_l_a2:
    s_add_u32 s34, s34, 102400
    s_mul_i32 s39, s20, 6
    s_add_u32 s39, s39, 0
    s_lshr_b32 s37, s39, 1
    s_and_b32 s38, s39, 1
    s_mul_i32 s38, s38, 24
    s_add_u32 s37, s37, s38
    s_mul_i32 s46, s37, 5120
    s_add_u32 s46, s46, s34
    s_mul_i32 s39, s20, 6
    s_add_u32 s39, s39, 1
    s_lshr_b32 s37, s39, 1
    s_and_b32 s38, s39, 1
    s_mul_i32 s38, s38, 24
    s_add_u32 s37, s37, s38
    s_mul_i32 s47, s37, 5120
    s_add_u32 s47, s47, s34
    s_mul_i32 s39, s20, 6
    s_add_u32 s39, s39, 2
    s_lshr_b32 s37, s39, 1
    s_and_b32 s38, s39, 1
    s_mul_i32 s38, s38, 24
    s_add_u32 s37, s37, s38
    s_mul_i32 s48, s37, 5120
    s_add_u32 s48, s48, s34
    s_mul_i32 s39, s20, 6
    s_add_u32 s39, s39, 3
    s_lshr_b32 s37, s39, 1
    s_and_b32 s38, s39, 1
    s_mul_i32 s38, s38, 24
    s_add_u32 s37, s37, s38
    s_mul_i32 s49, s37, 5120
    s_add_u32 s49, s49, s34
    s_mul_i32 s39, s20, 6
    s_add_u32 s39, s39, 4
    s_lshr_b32 s37, s39, 1
    s_and_b32 s38, s39, 1
    s_mul_i32 s38, s38, 24
    s_add_u32 s37, s37, s38
    s_mul_i32 s50, s37, 5120
    s_add_u32 s50, s50, s34
    s_mul_i32 s39, s20, 6
    s_add_u32 s39, s39, 5
    s_lshr_b32 s37, s39, 1
    s_and_b32 s38, s39, 1
    s_mul_i32 s38, s38, 24
    s_add_u32 s37, s37, s38
    s_mul_i32 s51, s37, 5120
    s_add_u32 s51, s51, s34
    s_mul_i32 s32, s20, 30720
    v_add_u32 v2, s32, v1
    s_lshl_b32 s39, s20, 1
    s_add_u32 s39, s39, 24
    s_lshr_b32 s37, s39, 1
    s_and_b32 s38, s39, 1
    s_mul_i32 s38, s38, 24
    s_add_u32 s37, s37, s38
    s_mul_i32 s32, s37, 5120
    s_add_u32 s32, s32, s34
    s_mul_i32 s33, s39, 5120
    s_add_u32 s39, s39, 1
    s_lshr_b32 s37, s39, 1
    s_and_b32 s38, s39, 1
    s_mul_i32 s38, s38, 24
    s_add_u32 s37, s37, s38
    s_mul_i32 s42, s37, 5120
    s_add_u32 s42, s42, s34
    s_waitcnt vmcnt(0)
    s_barrier
    s_mov_b64 exec, 1
    buffer_store_dword v23, v7, s[8:11], s57 offen sc1
    s_mov_b64 exec, -1
    s_mov_b32 s52, s32
    s_cmp_eq_u32 s20, 0
    s_cbranch_scc0 sequential_preLN__mha_block__glu_gated_geglu__prompt_kernel_l_w5a_go
    s_add_u32 s33, s33, 5120
    s_branch sequential_preLN__mha_block__glu_gated_geglu__prompt_kernel_l_w5a_no
sequential_preLN__mha_block__glu_gated_geglu__prompt_kernel_l_w5a_go:
    s_mov_b32 s35, 5
sequential_preLN__mha_block__glu_gated_geglu__prompt_kernel_l_w5a:
    s_mov_b32 m0, s33
    s_add_u32 s33, s33, 1024
    buffer_load_dwordx4 v1, s[8:11], s32 offen sc1 lds
    s_add_u32 s32, s32, 1024
    s_sub_u32 s35, s35, 1
    s_cmp_lg_u32 s35, 0
    s_cbranch_scc1 sequential_preLN__mha_block__glu_gated_geglu__prompt_kernel_l_w5a
sequential_preLN__mha_block__glu_gated_geglu__prompt_kernel_l_w5a_no:
    s_mov_b32 s32, s42
    s_mov_b32 s35, 5
sequential_preLN__mha_block__glu_gated_geglu__prompt_kernel_l_w5b:
    s_mov_b32 m0, s33
    s_add_u32 s33, s33, 1024
    buffer_load_dwordx4 v1, s[8:11], s32 offen sc1 lds
    s_add_u32 s32, s32, 1024
    s_sub_u32 s35, s35, 1
    s_cmp_lg_u32 s35, 0
    s_cbranch_scc1 sequential_preLN__mha_block__glu_gated_geglu__prompt_kernel_l_w5b
    buffer_load_dwordx4 v[28:31], v1, s[8:11], s51 offen offset:0 sc1
    buffer_load_dwordx4 v[152:155], v1, s[8:11], s51 offen offset:1024 sc1
    buffer_load_dwordx4 v[156:159], v1, s[8:11], s51 offen offset:2048 sc1
    buffer_load_dwordx4 v[160:163], v1, s[8:11], s51 offen offset:3072 sc1
    s_add_u32 s51, s51, 4096
    buffer_load_dwordx4 v[164:167], v1, s[8:11], s51 offen offset:0 sc1
    s_cmp_eq_u32 s20, 0
    s_cbranch_scc0 sequential_preLN__mha_block__glu_gated_geglu__prompt_kernel_l_win2_end
    s_lshl_b32 s40, s6, 12
    s_add_u32 s40, s40, 19517440
    s_mov_b64 exec, 0xffffffff
    s_mov_b32 s41, 262144
sequential_preLN__mha_block__glu_gated_geglu__prompt_kernel_poll1:
    buffer_load_dword v8, v4, s[8:11], s40 offen sc1
    s_sub_u32 s41, s41, 1
    s_cbranch_scc1 sequential_preLN__mha_block__glu_gated_geglu__prompt_kernel_polled1
    s_waitcnt vmcnt(0)
    v_cmp_ne_u32 vcc, 1, v8
    s_nop 1
    s_cbranch_vccz sequential_preLN__mha_block__glu_gated_geglu__prompt_kernel_polled1
    s_mov_b64 exec, vcc
    s_sleep 4
    s_branch sequential_preLN__mha_block__glu_gated_geglu__prompt_kernel_poll1
sequential_preLN__mha_block__glu_gated_geglu__prompt_kernel_polled1:
    s_mov_b64 exec, -1
sequential_preLN__mha_block__glu_gated_geglu__prompt_kernel_l_win2_end:
    s_barrier
    s_barrier
    s_cmp_eq_u32 s20, 3
    s_cbranch_scc1 sequential_preLN__mha_block__glu_gated_geglu__prompt_kernel_l_late
    ds_write_b128 v2, v[32:35] offset:0
    ds_write_b128 v2, v[36:39] offset:1024
    ds_write_b128 v2, v[40:43] offset:2048
    ds_write_b128 v2, v[44:47] offset:3072
    ds_write_b128 v2, v[48:51] offset:4096
    ds_write_b128 v2, v[52:55] offset:5120
    ds_write_b128 v2, v[56:59] offset:6144
    ds_write_b128 v2, v[60:63] offset:7168
    s_waitcnt lgkmcnt(4)
    ds_write_b128 v2, v[64:67] offset:8192
    ds_write_b128 v2, v[68:71] offset:9216
    ds_write_b128 v2, v[72:75] offset:10240
    ds_write_b128 v2, v[76:79] offset:11264
    ds_write_b128 v2, v[80:83] offset:12288
    ds_write_b128 v2, v[84:87] offset:13312
    ds_write_b128 v2, v[88:91] offset:14336
    ds_write_b128 v2, v[92:95] offset:15360
    s_waitcnt lgkmcnt(4)
    ds_write_b128 v2, v[96:99] offset:16384
    ds_write_b128 v2, v[100:103] offset:17408
    ds_write_b128 v2, v[104:107] offset:18432
    ds_write_b128 v2, v[108:111] offset:19456
    ds_write_b128 v2, v[112:115] offset:20480
    ds_write_b128 v2, v[116:119] offset:21504
    ds_write_b128 v2, v[120:123] offset:22528
    ds_write_b128 v2, v[124:127] offset:23552
    s_waitcnt lgkmcnt(4)
    ds_write_b128 v2, v[128:131] offset:24576
    ds_write_b128 v2, v[132:135] offset:25600
    ds_write_b128 v2, v[136:139] offset:26624
    ds_write_b128 v2, v[140:143] offset:27648
    ds_write_b128 v2, v[144:147] offset:28672
    ds_write_b128 v2, v[148:151] offset:29696
    s_waitcnt lgkmcnt(0)
    s_barrier
    s_mov_b64 exec, 1
    buffer_store_dword v23, v7, s[8:11], s58 offen sc1
    s_mov_b64 exec, -1
    s_branch sequential_preLN__mha_block__glu_gated_geglu__prompt_kernel_l_a3
sequential_preLN__mha_block__glu_gated_geglu__prompt_kernel_l_late:
    s_barrier
    ds_write_b128 v2, v[32:35] offset:0
    ds_write_b128 v2, v[36:39] offset:1024
    ds_write_b128 v2, v[40:43] offset:2048
    ds_write_b128 v2, v[44:47] offset:3072
    ds_write_b128 v2, v[48:51] offset:4096
    ds_write_b128 v2, v[52:55] offset:5120
    ds_write_b128 v2, v[56:59] offset:6144
    ds_write_b128 v2, v[60:63] offset:7168
    s_waitcnt lgkmcnt(4)
    ds_write_b128 v2, v[64:67] offset:8192
    ds_write_b128 v2, v[68:71] offset:9216
    ds_write_b128 v2, v[72:75] offset:10240
    ds_write_b128 v2, v[76:79] offset:11264
    ds_write_b128 v2, v[80:83] offset:12288
    ds_write_b128 v2, v[84:87] offset:13312
    ds_write_b128 v2, v[88:91] offset:14336
    ds_write_b128 v2, v[92:95] offset:15360
    s_waitcnt lgkmcnt(4)
    ds_write_b128 v2, v[96:99] offset:16384
    ds_write_b128 v2, v[100:103] offset:17408
    ds_write_b128 v2, v[104:107] offset:18432
    ds_write_b128 v2, v[108:111] offset:19456
    ds_write_b128 v2, v[112:115] offset:20480
    ds_write_b128 v2, v[116:119] offset:21504
    ds_write_b128 v2, v[120:123] offset:22528
    ds_write_b128 v2, v[124:127] offset:23552
    s_waitcnt lgkmcnt(4)
    ds_write_b128 v2, v[128:131] offset:24576
    ds_write_b128 v2, v[132:135] offset:25600
    ds_write_b128 v2, v[136:139] offset:26624
    ds_write_b128 v2, v[140:143] offset:27648
    ds_write_b128 v2, v[144:147] offset:28672
    ds_write_b128 v2, v[148:151] offset:29696
    s_waitcnt lgkmcnt(0)
sequential_preLN__mha_block__glu_gated_geglu__prompt_kernel_l_a3:
    s_cmp_eq_u32 s20, 0
    s_cbranch_scc0 sequential_preLN__mha_block__glu_gated_geglu__prompt_kernel_l_w5c_no
    s_mov_b32 s32, s52
    s_mov_b32 s33, 122880
    s_mov_b32 s35, 5
sequential_preLN__mha_block__glu_gated_geglu__prompt_kernel_l_w5c:
    s_mov_b32 m0, s33
    s_add_u32 s33, s33, 1024
    buffer_load_dwordx4 v1, s[8:11], s32 offen sc1 lds
    s_add_u32 s32, s32, 1024
    s_sub_u32 s35, s35, 1
    s_cmp_lg_u32 s35, 0
    s_cbranch_scc1 sequential_preLN__mha_block__glu_gated_geglu__prompt_kernel_l_w5c
sequential_preLN__mha_block__glu_gated_geglu__prompt_kernel_l_w5c_no:
    buffer_load_dwordx4 v[32:35], v1, s[8:11], s46 offen offset:0 sc1
    buffer_load_dwordx4 v[36:39], v1, s[8:11], s46 offen offset:1024 sc1
    buffer_load_dwordx4 v[40:43], v1, s[8:11], s46 offen offset:2048 sc1
    buffer_load_dwordx4 v[44:47], v1, s[8:11], s46 offen offset:3072 sc1
    s_add_u32 s46, s46, 4096
    buffer_load_dwordx4 v[48:51], v1, s[8:11], s46 offen offset:0 sc1
    buffer_load_dwordx4 v[52:55], v1, s[8:11], s47 offen offset:0 sc1
    buffer_load_dwordx4 v[56:59], v1, s[8:11], s47 offen offset:1024 sc1
    buffer_load_dwordx4 v[60:63], v1, s[8:11], s47 offen offset:2048 sc1
    buffer_load_dwordx4 v[64:67], v1, s[8:11], s47 offen offset:3072 sc1
    s_add_u32 s47, s47, 4096
    buffer_load_dwordx4 v[68:71], v1, s[8:11], s47 offen offset:0 sc1
    buffer_load_dwordx4 v[72:75], v1, s[8:11], s48 offen offset:0 sc1
    buffer_load_dwordx4 v[76:79], v1, s[8:11], s48 offen offset:1024 sc1
    buffer_load_dwordx4 v[80:83], v1, s[8:11], s48 offen offset:2048 sc1
    buffer_load_dwordx4 v[84:87], v1, s[8:11], s48 offen offset:3072 sc1
    s_add_u32 s48, s48, 4096
    buffer_load_dwordx4 v[88:91], v1, s[8:11], s48 offen offset:0 sc1
    buffer_load_dwordx4 v[92:95], v1, s[8:11], s49 offen offset:0 sc1
    buffer_load_dwordx4 v[96:99], v1, s[8:11], s49 offen offset:1024 sc1
    buffer_load_dwordx4 v[100:103], v1, s[8:11], s49 offen offset:2048 sc1
    buffer_load_dwordx4 v[104:107], v1, s[8:11], s49 offen offset:3072 sc1
    s_add_u32 s49, s49, 4096
    buffer_load_dwordx4 v[108:111], v1, s[8:11], s49 offen offset:0 sc1
    buffer_load_dwordx4 v[112:115], v1, s[8:11], s50 offen offset:0 sc1
    buffer_load_dwordx4 v[116:119], v1, s[8:11], s50 offen offset:1024 sc1
    buffer_load_dwordx4 v[120:123], v1, s[8:11], s50 offen offset:2048 sc1
    buffer_load_dwordx4 v[124:127], v1, s[8:11], s50 offen offset:3072 sc1
    s_add_u32 s50, s50, 4096
    buffer_load_dwordx4 v[128:131], v1, s[8:11], s50 offen offset:0 sc1
    s_cmp_eq_u32 s20, 2
    s_cbranch_scc0 sequential_preLN__mha_block__glu_gated_geglu__prompt_kernel_l_win4_end
    s_lshl_b32 s40, s74, 12
    s_add_u32 s40, s40, 19550208
    s_mov_b64 exec, 0xffffffff
    s_mov_b32 s41, 262144
sequential_preLN__mha_block__glu_gated_geglu__prompt_kernel_poll2:
    buffer_load_dword v8, v4, s[8:11], s40 offen sc1
    s_sub_u32 s41, s41, 1
    s_cbranch_scc1 sequential_preLN__mha_block__glu_gated_geglu__prompt_kernel_polled2
    s_waitcnt vmcnt(0)
    v_cmp_ne_u32 vcc, 1, v8
    s_nop 1
    s_cbranch_vccz sequential_preLN__mha_block__glu_gated_geglu__prompt_kernel_polled2
    s_mov_b64 exec, vcc
    s_sleep 4
    s_branch sequential_preLN__mha_block__glu_gated_geglu__prompt_kernel_poll2
sequential_preLN__mha_block__glu_gated_geglu__prompt_kernel_polled2:
    s_mov_b64 exec, -1
sequential_preLN__mha_block__glu_gated_geglu__prompt_kernel_l_win4_end:
    s_barrier
    s_lshl_b32 s39, s20, 1
    s_add_u32 s39, s39, 32
    s_lshr_b32 s37, s39, 1
    s_and_b32 s38, s39, 1
    s_mul_i32 s38, s38, 24
    s_add_u32 s37, s37, s38
    s_mul_i32 s46, s37, 5120
    s_add_u32 s46, s46, s34
    s_lshl_b32 s39, s20, 1
    s_add_u32 s39, s39, 33
    s_lshr_b32 s37, s39, 1
    s_and_b32 s38, s39, 1
    s_mul_i32 s38, s38, 24
    s_add_u32 s37, s37, s38
    s_mul_i32 s47, s37, 5120
    s_add_u32 s47, s47, s34
    s_lshl_b32 s39, s20, 1
    s_add_u32 s39, s39, 40
    s_lshr_b32 s37, s39, 1
    s_and_b32 s38, s39, 1
    s_mul_i32 s38, s38, 24
    s_add_u32 s37, s37, s38
    s_mul_i32 s48, s37, 5120
    s_add_u32 s48, s48, s34
    s_lshl_b32 s39, s20, 1
    s_add_u32 s39, s39, 41
    s_lshr_b32 s37, s39, 1
    s_and_b32 s38, s39, 1
    s_mul_i32 s38, s38, 24
    s_add_u32 s37, s37, s38
    s_mul_i32 s49, s37, 5120
    s_add_u32 s49, s49, s34
    s_waitcnt vmcnt(0)
    s_barrier
    ds_write_b128 v2, v[32:35] offset:0
    ds_write_b128 v2, v[36:39] offset:1024
    ds_write_b128 v2, v[40:43] offset:2048
    ds_write_b128 v2, v[44:47] offset:3072
    ds_write_b128 v2, v[48:51] offset:4096
    ds_write_b128 v2, v[52:55] offset:5120
    ds_write_b128 v2, v[56:59] offset:6144
    ds_write_b128 v2, v[60:63] offset:7168
    s_waitcnt lgkmcnt(4)
    ds_write_b128 v2, v[64:67] offset:8192
    ds_write_b128 v2, v[68:71] offset:9216
    ds_write_b128 v2, v[72:75] offset:10240
    ds_write_b128 v2, v[76:79] offset:11264
    ds_write_b128 v2, v[80:83] offset:12288
    ds_write_b128 v2, v[84:87] offset:13312
    ds_write_b128 v2, v[88:91] offset:14336
    ds_write_b128 v2, v[92:95] offset:15360
    s_waitcnt lgkmcnt(4)
    ds_write_b128 v2, v[96:99] offset:16384
    ds_write_b128 v2, v[100:103] offset:17408
    ds_write_b128 v2, v[104:107] offset:18432
    ds_write_b128 v2, v[108:111] offset:19456
    ds_write_b128 v2, v[112:115] offset:20480
    ds_write_b128 v2, v[116:119] offset:21504
    ds_write_b128 v2, v[120:123] offset:22528
    ds_write_b128 v2, v[124:127] offset:23552
    s_waitcnt lgkmcnt(4)
    ds_write_b128 v2, v[128:131] offset:24576
    ds_write_b128 v2, v[28:31] offset:25600
    ds_write_b128 v2, v[152:155] offset:26624
    ds_write_b128 v2, v[156:159] offset:27648
    ds_write_b128 v2, v[160:163] offset:28672
    ds_write_b128 v2, v[164:167] offset:29696
    s_waitcnt lgkmcnt(0)
    s_barrier
    s_mov_b64 exec, 1
    buffer_store_dword v23, v7, s[8:11], s59 offen sc1
    s_mov_b64 exec, -1
    buffer_load_dwordx4 v[32:35], v1, s[8:11], s46 offen offset:0 sc1
    buffer_load_dwordx4 v[36:39], v1, s[8:11], s46 offen offset:1024 sc1
    buffer_load_dwordx4 v[40:43], v1, s[8:11], s46 offen offset:2048 sc1
    buffer_load_dwordx4 v[44:47], v1, s[8:11], s46 offen offset:3072 sc1
    s_add_u32 s46, s46, 4096
    buffer_load_dwordx4 v[48:51], v1, s[8:11], s46 offen offset:0 sc1
    buffer_load_dwordx4 v[52:55], v1, s[8:11], s47 offen offset:0 sc1
    buffer_load_dwordx4 v[56:59], v1, s[8:11], s47 offen offset:1024 sc1
    buffer_load_dwordx4 v[60:63], v1, s[8:11], s47 offen offset:2048 sc1
    buffer_load_dwordx4 v[64:67], v1, s[8:11], s47 offen offset:3072 sc1
    s_add_u32 s47, s47, 4096
    buffer_load_dwordx4 v[68:71], v1, s[8:11], s47 offen offset:0 sc1
    buffer_load_dwordx4 v[72:75], v1, s[8:11], s48 offen offset:0 sc1
    buffer_load_dwordx4 v[76:79], v1, s[8:11], s48 offen offset:1024 sc1
    buffer_load_dwordx4 v[80:83], v1, s[8:11], s48 offen offset:2048 sc1
    buffer_load_dwordx4 v[84:87], v1, s[8:11], s48 offen offset:3072 sc1
    s_add_u32 s48, s48, 4096
    buffer_load_dwordx4 v[88:91], v1, s[8:11], s48 offen offset:0 sc1
    buffer_load_dwordx4 v[92:95], v1, s[8:11], s49 offen offset:0 sc1
    buffer_load_dwordx4 v[96:99], v1, s[8:11], s49 offen offset:1024 sc1
    buffer_load_dwordx4 v[100:103], v1, s[8:11], s49 offen offset:2048 sc1
    buffer_load_dwordx4 v[104:107], v1, s[8:11], s49 offen offset:3072 sc1
    s_add_u32 s49, s49, 4096
    buffer_load_dwordx4 v[108:111], v1, s[8:11], s49 offen offset:0 sc1
    s_cmp_eq_u32 s20, 0
    s_cbranch_scc0 sequential_preLN__mha_block__glu_gated_geglu__prompt_kernel_l_win6_end
    s_lshl_b32 s40, s6, 12
    s_add_u32 s40, s40, 19582976
    s_mov_b64 exec, 0xffffffff
    s_mov_b32 s41, 262144
sequential_preLN__mha_block__glu_gated_geglu__prompt_kernel_poll3:
    buffer_load_dword v8, v4, s[8:11], s40 offen sc1
    s_sub_u32 s41, s41, 1
    s_cbranch_scc1 sequential_preLN__mha_block__glu_gated_geglu__prompt_kernel_polled3
    s_waitcnt vmcnt(0)
    v_cmp_ne_u32 vcc, 1, v8
    s_nop 1
    s_cbranch_vccz sequential_preLN__mha_block__glu_gated_geglu__prompt_kernel_polled3
    s_mov_b64 exec, vcc
    s_sleep 4
    s_branch sequential_preLN__mha_block__glu_gated_geglu__prompt_kernel_poll3
sequential_preLN__mha_block__glu_gated_geglu__prompt_kernel_polled3:
    s_mov_b64 exec, -1
sequential_preLN__mha_block__glu_gated_geglu__prompt_kernel_l_win6_end:
    s_barrier
    s_mul_i32 s32, s20, 10240
    v_add_u32 v2, s32, v1
    s_waitcnt vmcnt(0)
    s_barrier
    ds_write_b128 v2, v[32:35] offset:0
    ds_write_b128 v2, v[36:39] offset:1024
    ds_write_b128 v2, v[40:43] offset:2048
    ds_write_b128 v2, v[44:47] offset:3072
    ds_write_b128 v2, v[48:51] offset:4096
    ds_write_b128 v2, v[52:55] offset:5120
    ds_write_b128 v2, v[56:59] offset:6144
    ds_write_b128 v2, v[60:63] offset:7168
    ds_write_b128 v2, v[64:67] offset:8192
    ds_write_b128 v2, v[68:71] offset:9216
    s_waitcnt lgkmcnt(0)
    s_barrier
    ds_write_b128 v2, v[72:75] offset:40960
    ds_write_b128 v2, v[76:79] offset:41984
    ds_write_b128 v2, v[80:83] offset:43008
    ds_write_b128 v2, v[84:87] offset:44032
    ds_write_b128 v2, v[88:91] offset:45056
    ds_write_b128 v2, v[92:95] offset:46080
    ds_write_b128 v2, v[96:99] offset:47104
    ds_write_b128 v2, v[100:103] offset:48128
    ds_write_b128 v2, v[104:107] offset:49152
    ds_write_b128 v2, v[108:111] offset:50176
    s_waitcnt lgkmcnt(0)
    s_barrier
    s_endpgm
sequential_preLN__mha_block__glu_gated_geglu__prompt_kernel_flip:
    s_setprio 0
    s_bitcmp0_b32 s38, s22
    s_cbranch_scc1 sequential_preLN__mha_block__glu_gated_geglu__prompt_kernel_flipback
    s_setprio 1
    s_branch sequential_preLN__mha_block__glu_gated_geglu__prompt_kernel_flipback
sequential_preLN__mha_block__glu_gated_geglu__prompt_kernel_slow:
    v_subrev_u32 v4, 163840, v4
    v_mov_b32 v15, 0xff7fffff
    s_mov_b32 s37, 0
sequential_preLN__mha_block__glu_gated_geglu__prompt_kernel_slow_pass:
    s_mov_b32 s22, 0
sequential_preLN__mha_block__glu_gated_geglu__prompt_kernel_slow_tile:
    s_lshr_b32 s40, s22, 3
    s_mul_i32 s40, s40, 20480
    s_add_u32 s40, s40, s25
    s_and_b32 s41, s22, 7
    s_lshl_b32 s48, s41, 10
    s_add_u32 s48, s48, s40
    s_lshl_b32 s49, s41, 8
    s_add_u32 s49, s49, s40
    s_add_u32 s49, s49, 8192
    s_mul_i32 s50, s41, 1280
    s_add_u32 s50, s50, s40
    buffer_load_dwordx4 v[88:91], v1, s[8:11], s48 offen sc1
    buffer_load_dwordx2 v[92:93], v9, s[8:11], s49 offen sc1
    s_cmp_eq_u32 s37, 0
    s_cbranch_scc0 sequential_preLN__mha_block__glu_gated_geglu__prompt_kernel_slow_pv
    s_waitcnt vmcnt(0)
    v_mfma_f32_32x32x16_bf16 v[48:63], v[88:91], v[80:83], 0
    v_mfma_f32_32x32x8bf16_1k v[48:63], v[92:93], v[84:85], v[48:63]
    s_nop 11
    v_max3_f32 v15, v15, v48, v49
    v_max3_f32 v15, v15, v50, v51
    v_max3_f32 v15, v15, v52, v53
    v_max3_f32 v15, v15, v54, v55
    v_max3_f32 v15, v15, v56, v57
    v_max3_f32 v15, v15, v58, v59
    v_max3_f32 v15, v15, v60, v61
    v_max3_f32 v15, v15, v62, v63
    s_branch sequential_preLN__mha_block__glu_gated_geglu__prompt_kernel_slow_next
sequential_preLN__mha_block__glu_gated_geglu__prompt_kernel_slow_pv:
    s_mov_b64 exec, s[34:35]
    buffer_load_dwordx4 v[96:99], v4, s[8:11], s50 offen offset:0 sc1
    buffer_load_dwordx4 v[100:103], v4, s[8:11], s50 offen offset:640 sc1
    s_mov_b64 exec, -1
    s_waitcnt vmcnt(0)
    v_mfma_f32_32x32x16_bf16 v[48:63], v[88:91], v[80:83], v[32:47]
    v_mfma_f32_32x32x8bf16_1k v[48:63], v[92:93], v[84:85], v[48:63]
    s_nop 11
    v_exp_f32 v48, v48
    v_exp_f32 v49, v49
    v_exp_f32 v50, v50
    v_exp_f32 v51, v51
    v_exp_f32 v52, v52
    v_exp_f32 v53, v53
    v_exp_f32 v54, v54
    v_exp_f32 v55, v55
    v_exp_f32 v56, v56
    v_exp_f32 v57, v57
    v_exp_f32 v58, v58
    v_exp_f32 v59, v59
    v_exp_f32 v60, v60
    v_exp_f32 v61, v61
    v_exp_f32 v62, v62
    v_exp_f32 v63, v63
    s_nop 1
    v_smfmac_f32_32x32x32_bf16 v[16:31], v[96:99], v[48:55], v6
    v_smfmac_f32_32x32x32_bf16 v[16:31], v[100:103], v[56:63], v6
    s_nop 3
sequential_preLN__mha_block__glu_gated_geglu__prompt_kernel_slow_next:
    s_add_u32 s22, s22, 1
    s_cmp_lt_u32 s22, 64
    s_cbranch_scc1 sequential_preLN__mha_block__glu_gated_geglu__prompt_kernel_slow_tile
    s_cmp_eq_u32 s37, 0
    s_cbranch_scc0 sequential_preLN__mha_block__glu_gated_geglu__prompt_kernel_slow_done
    v_mov_b32 v11, v15
    s_nop 1
    v_permlane32_swap_b32 v15, v11
    v_max_f32 v15, v15, v11
    v_sub_f32 v32, 0, v15
    v_mov_b32 v16, 0
    v_sub_f32 v33, 0, v15
    v_mov_b32 v17, 0
    v_sub_f32 v34, 0, v15
    v_mov_b32 v18, 0
    v_sub_f32 v35, 0, v15
    v_mov_b32 v19, 0
    v_sub_f32 v36, 0, v15
    v_mov_b32 v20, 0
    v_sub_f32 v37, 0, v15
    v_mov_b32 v21, 0
    v_sub_f32 v38, 0, v15
    v_mov_b32 v22, 0
    v_sub_f32 v39, 0, v15
    v_mov_b32 v23, 0
    v_sub_f32 v40, 0, v15
    v_mov_b32 v24, 0
    v_sub_f32 v41, 0, v15
    v_mov_b32 v25, 0
    v_sub_f32 v42, 0, v15
    v_mov_b32 v26, 0
    v_sub_f32 v43, 0, v15
    v_mov_b32 v27, 0
    v_sub_f32 v44, 0, v15
    v_mov_b32 v28, 0
    v_sub_f32 v45, 0, v15
    v_mov_b32 v29, 0
    v_sub_f32 v46, 0, v15
    v_mov_b32 v30, 0
    v_sub_f32 v47, 0, v15
    v_mov_b32 v31, 0
    s_mov_b32 s37, 1
    s_branch sequential_preLN__mha_block__glu_gated_geglu__prompt_kernel_slow_pass
sequential_preLN__mha_block__glu_gated_geglu__prompt_kernel_slow_done:
    s_nop 11
    v_cndmask_b32 v12, v24, v28, s[38:39]
    v_rcp_f32 v10, v12
    s_branch sequential_preLN__mha_block__glu_gated_geglu__prompt_kernel_finish
sequential_preLN__mha_block__glu_gated_geglu__prompt_kernel_codeend:
.section .rodata,"a"
.p2align 6
.amdhsa_kernel sequential_preLN__mha_block__glu_gated_geglu__prompt_kernel
  .amdhsa_next_free_vgpr 168
  .amdhsa_next_free_sgpr 102
  .amdhsa_accum_offset 168
  .amdhsa_group_segment_fixed_size 0
  .amdhsa_kernarg_size 80
  .amdhsa_user_sgpr_count 2
  .amdhsa_user_sgpr_kernarg_segment_ptr 1
  .amdhsa_system_sgpr_workgroup_id_x 1
.end_amdhsa_kernel
```
